```python
import torch

def _softmax(x, axis=-1):
    return torch.softmax(x, dim=axis)

def _gelu(x):
    return torch.nn.functional.gelu(x, approximate='tanh')

def _silu(x):
    return torch.nn.functional.silu(x)

def _sigmoid(x):
    return torch.sigmoid(x)

def _layernorm(x, axis=-1, eps=1e-05):
    m = x.mean(dim=axis, keepdim=True)
    v = x.var(dim=axis, keepdim=True, unbiased=False)
    return (x - m) / torch.sqrt(v + eps)

def _scatter_add(tgt, idx, src, axis=0):
    return tgt.clone().index_add_(axis, idx, src)

def _segment_sum(src, seg, n):
    out = torch.zeros((n,) + src.shape[1:], dtype=src.dtype)
    return out.index_add_(0, seg, src)

def _pad(x, pw):
    flat = tuple((v for pair in reversed(pw) for v in pair))
    return torch.nn.functional.pad(x, flat)
kernel_name = 'gated_mix__memory_aug_recurrent_mem_tr__glu_gated_reglu__prompt'

def setup_inputs():

    _w = lambda a: (lambda t: t.to(torch.bfloat16) if t.is_floating_point() else t)(torch.as_tensor(a))

    def _A_setup():
        B, S, Dm = (1, 2048, 512)
        H, Dh = (32, 128)
        M, seg = (8, 32)
        seg = min(seg, S)
        S = S // seg * seg
        return {'x': _w((lambda *s: torch.randn(*s, dtype=torch.bfloat16) * 0.05)(B, S, Dm)), 'mem0': _w((lambda *s: torch.randn(*s, dtype=torch.bfloat16) * 0.4)(B, M, Dm)), 'Wq': _w((lambda *s: torch.randn(*s, dtype=torch.bfloat16) * 6.4)(Dm, H, Dh) * Dm ** (-0.5)), 'Wk': _w((lambda *s: torch.randn(*s, dtype=torch.bfloat16) * 6.4)(Dm, H, Dh) * Dm ** (-0.5)), 'Wv': _w((lambda *s: torch.randn(*s, dtype=torch.bfloat16) * 0.4)(Dm, H, Dh) * Dm ** (-0.5)), 'Wo': _w((lambda *s: torch.randn(*s, dtype=torch.bfloat16) * 0.4)(H, Dh, Dm) * (H * Dh) ** (-0.5)), 'seg_len': seg}
    _A_in = _A_setup()

    def _B_setup():
        B, S, D, F = (1, 2048, 512, 1792)
        return {'x': _w((lambda *s: torch.randn(*s, dtype=torch.bfloat16) * 0.05)(B, S, D)), 'W_gate': _w((lambda *s: torch.randn(*s, dtype=torch.bfloat16) * 0.8)(D, F) * (2.0 / D) ** 0.5), 'W_up': _w((lambda *s: torch.randn(*s, dtype=torch.bfloat16) * 0.8)(D, F) * (2.0 / D) ** 0.5), 'W_down': _w((lambda *s: torch.randn(*s, dtype=torch.bfloat16) * 0.8)(F, D) * (1.0 / F) ** 0.5)}
    _B_in = _B_setup()
    return {'A_x': _A_in['x'], 'A_mem0': _A_in['mem0'], 'A_Wq': _A_in['Wq'], 'A_Wk': _A_in['Wk'], 'A_Wv': _A_in['Wv'], 'A_Wo': _A_in['Wo'], 'A_seg_len': _A_in['seg_len'], 'B_x': _B_in['x'], 'B_W_gate': _B_in['W_gate'], 'B_W_up': _B_in['W_up'], 'B_W_down': _B_in['W_down'], 'gate_w': _w((lambda *s: torch.randn(*s, dtype=torch.bfloat16) * 0.05)(512) * 16.0)}

def reference(A_x, A_mem0, A_Wq, A_Wk, A_Wv, A_Wo, A_seg_len, B_x, B_W_gate, B_W_up, B_W_down, gate_w):

    def _A_ref(x, mem0, Wq, Wk, Wv, Wo, seg_len):
        B, S, Dm = x.shape
        H, Dh = (Wq.shape[1], Wq.shape[2])
        M = mem0.shape[1]
        scale = Dh ** (-0.5)
        n_seg = S // seg_len
        L = M + seg_len
        idx = torch.arange(L)
        mask = (idx[:, None] < M) | (idx[:, None] >= idx[None, :])
        mem = mem0
        outs = []
        for s in range(n_seg):
            xs = x[:, s * seg_len:(s + 1) * seg_len, :].clone()
            h = torch.concatenate([mem, xs], axis=1)
            q = torch.einsum('btd,dhe->bhte', h, Wq)
            k = torch.einsum('btd,dhe->bhte', h, Wk)
            v = torch.einsum('btd,dhe->bhte', h, Wv)
            scores = torch.einsum('bhqe,bhke->bhqk', q, k) * scale
            scores = torch.where(mask[None, None], scores, -1000000000.0)
            p = _softmax(scores, axis=-1)
            o = torch.einsum('bhqk,bhke->bhqe', p, v)
            o = torch.einsum('bhte,hed->btd', o, Wo)
            mem = o[:, :M, :].clone()
            outs.append(o[:, M:, :])
        return torch.concatenate(outs, axis=1)

    def _B_ref(x, W_gate, W_up, W_down):
        gate = torch.einsum('bsd,df->bsf', x, W_gate)
        up = torch.einsum('bsd,df->bsf', x, W_up)
        gate = gate * (lambda x, dt: x.to(dt))(gate > 0, gate.dtype)
        h = gate * up
        return torch.einsum('bsf,fd->bsd', h, W_down)
    x = A_x
    g = _sigmoid((x * gate_w).sum(-1, keepdims=True))
    a = _A_ref(x, A_mem0, A_Wq, A_Wk, A_Wv, A_Wo, A_seg_len)
    b = _B_ref(x, B_W_gate, B_W_up, B_W_down)
    return g * a + (1 - g) * b
```

```asm
; @launch grid=(256,1,1) block=(256,1,1) lds=163840
.amdgcn_target "amdgcn-amd-amdhsa--gfx950"
.text
.globl gated_mix__memory_aug_recurrent_mem_tr__glu_gated_reglu__prompt_kernel
.p2align 8
.type gated_mix__memory_aug_recurrent_mem_tr__glu_gated_reglu__prompt_kernel,@function
gated_mix__memory_aug_recurrent_mem_tr__glu_gated_reglu__prompt_kernel:
  s_cmp_ge_u32 s2, 256
  s_cbranch_scc1 L_end
  s_load_dwordx2 s[32:33], s[0:1], 0
  s_load_dwordx2 s[24:25], s[0:1], 104
  s_load_dwordx2 s[34:35], s[0:1], 112
  s_load_dwordx8 s[80:87], s[0:1], 16
  s_load_dwordx2 s[88:89], s[0:1], 8
  s_load_dwordx4 s[68:71], s[0:1], 64
  s_getreg_b32 s27, hwreg(HW_REG_XCC_ID, 0, 3)
  v_lshrrev_b32 v1, 6, v0
  v_and_b32 v0, 63, v0
  v_readfirstlane_b32 s26, v1
  s_mov_b32 s29, 0
  s_mov_b32 s100, 400000
  s_xor_b32 s27, s27, 3
  s_waitcnt lgkmcnt(0)
  s_mov_b32 s4, s32
  s_and_b32 s5, s33, 0xffff
  s_mov_b32 s6, 2097152
  s_mov_b32 s7, 0x20000
  s_mov_b32 s8, s34
  s_and_b32 s9, s35, 0xffff
  s_mov_b32 s10, 268435456
  s_mov_b32 s11, 0x20000
  s_cmp_eq_u32 s26, 0
  s_cbranch_scc1 L_tk_w0
  s_branch L_tk_done
L_tk_w0:
  s_mov_b64 exec, 1
L_tk_loop:
  s_mul_i32 s36, s27, 24
  s_sub_u32 s36, s36, 24
  s_cmp_eq_u32 s27, 0
  s_cselect_b32 s36, 192, s36
  s_cmp_lg_u32 s29, 0
  s_cselect_b32 s37, 0x10001, 1
  v_mov_b32 v2, s36
  v_mov_b32 v3, s37
  global_atomic_add v4, v2, v3, s[24:25] sc0
  s_waitcnt vmcnt(0)
  v_readfirstlane_b32 s28, v4
  s_nop 0
  s_and_b32 s28, s28, 0xffff
  s_cmp_lt_u32 s28, 32
  s_cbranch_scc1 L_tk_got
  s_add_u32 s27, s27, 1
  s_and_b32 s27, s27, 7
  s_add_u32 s29, s29, 1
  s_cmp_lt_u32 s29, 8
  s_cbranch_scc1 L_tk_loop
L_tk_got:
  s_min_u32 s28, s28, 32
  s_lshl_b32 s36, s27, 8
  s_or_b32 s36, s36, s28
  v_mov_b32 v2, s36
  v_mov_b32 v3, 0
  ds_write_b32 v3, v2
  s_waitcnt lgkmcnt(0)
  s_mov_b64 exec, -1
L_tk_done:
  s_barrier
  v_mov_b32 v3, 0
  ds_read_b32 v2, v3
  s_waitcnt lgkmcnt(0)
  v_readfirstlane_b32 s36, v2
  s_barrier
  s_and_b32 s28, s36, 0xff
  s_lshr_b32 s27, s36, 8
  s_cmp_ge_u32 s28, 32
  s_cbranch_scc1 L_end
  s_cmp_eq_u32 s27, 0
  s_cbranch_scc1 L_team
  s_cmp_lg_u32 s27, 1
  s_cbranch_scc1 L_A_go
  s_cmp_lg_u32 s28, 0
  s_cbranch_scc1 L_A_idle2
  s_cmp_lg_u32 s26, 0
  s_cbranch_scc1 L_A_done
  s_memrealtime s[36:37]
  s_waitcnt lgkmcnt(0)
  s_mul_i32 s37, s36, 0x9E3779B1
  s_or_b32 s37, s37, 1
  v_mov_b32 v2, s36
  v_mov_b32 v3, s37
  v_mov_b32 v4, 208
  s_mov_b64 exec, 1
  global_store_dwordx2 v4, v[2:3], s[24:25] sc1
  s_mov_b64 exec, -1
  s_branch L_A_done
L_A_idle2:
  s_sub_u32 s36, s28, 4
  s_cmp_ge_u32 s36, 4
  s_cbranch_scc1 L_A_done
  s_lshl_b32 s36, s36, 2
  s_add_u32 s36, s36, s26
  s_lshl_b32 s37, s36, 11
  s_add_u32 s37, s37, 84934656
  s_lshl_b32 s36, s36, 15
  s_add_u32 s36, s36, 83886080
  v_lshlrev_b32 v2, 4, v0
  v_mov_b64 v[4:5], -1
  v_mov_b64 v[6:7], -1
  buffer_store_dwordx4 v[4:7], v2, s[8:11], s37 offen offset:0 sc1
  buffer_store_dwordx4 v[4:7], v2, s[8:11], s37 offen offset:1024 sc1
  buffer_store_dwordx4 v[4:7], v2, s[8:11], s36 offen offset:0 sc1
  buffer_store_dwordx4 v[4:7], v2, s[8:11], s36 offen offset:1024 sc1
  buffer_store_dwordx4 v[4:7], v2, s[8:11], s36 offen offset:2048 sc1
  buffer_store_dwordx4 v[4:7], v2, s[8:11], s36 offen offset:3072 sc1
  s_add_u32 s36, s36, 4096
  buffer_store_dwordx4 v[4:7], v2, s[8:11], s36 offen offset:0 sc1
  buffer_store_dwordx4 v[4:7], v2, s[8:11], s36 offen offset:1024 sc1
  buffer_store_dwordx4 v[4:7], v2, s[8:11], s36 offen offset:2048 sc1
  buffer_store_dwordx4 v[4:7], v2, s[8:11], s36 offen offset:3072 sc1
  s_add_u32 s36, s36, 4096
  buffer_store_dwordx4 v[4:7], v2, s[8:11], s36 offen offset:0 sc1
  buffer_store_dwordx4 v[4:7], v2, s[8:11], s36 offen offset:1024 sc1
  buffer_store_dwordx4 v[4:7], v2, s[8:11], s36 offen offset:2048 sc1
  buffer_store_dwordx4 v[4:7], v2, s[8:11], s36 offen offset:3072 sc1
  s_add_u32 s36, s36, 4096
  buffer_store_dwordx4 v[4:7], v2, s[8:11], s36 offen offset:0 sc1
  buffer_store_dwordx4 v[4:7], v2, s[8:11], s36 offen offset:1024 sc1
  buffer_store_dwordx4 v[4:7], v2, s[8:11], s36 offen offset:2048 sc1
  buffer_store_dwordx4 v[4:7], v2, s[8:11], s36 offen offset:3072 sc1
  s_add_u32 s36, s36, 4096
  buffer_store_dwordx4 v[4:7], v2, s[8:11], s36 offen offset:0 sc1
  buffer_store_dwordx4 v[4:7], v2, s[8:11], s36 offen offset:1024 sc1
  buffer_store_dwordx4 v[4:7], v2, s[8:11], s36 offen offset:2048 sc1
  buffer_store_dwordx4 v[4:7], v2, s[8:11], s36 offen offset:3072 sc1
  s_add_u32 s36, s36, 4096
  buffer_store_dwordx4 v[4:7], v2, s[8:11], s36 offen offset:0 sc1
  buffer_store_dwordx4 v[4:7], v2, s[8:11], s36 offen offset:1024 sc1
  buffer_store_dwordx4 v[4:7], v2, s[8:11], s36 offen offset:2048 sc1
  buffer_store_dwordx4 v[4:7], v2, s[8:11], s36 offen offset:3072 sc1
  s_add_u32 s36, s36, 4096
  buffer_store_dwordx4 v[4:7], v2, s[8:11], s36 offen offset:0 sc1
  buffer_store_dwordx4 v[4:7], v2, s[8:11], s36 offen offset:1024 sc1
  buffer_store_dwordx4 v[4:7], v2, s[8:11], s36 offen offset:2048 sc1
  buffer_store_dwordx4 v[4:7], v2, s[8:11], s36 offen offset:3072 sc1
  s_add_u32 s36, s36, 4096
  buffer_store_dwordx4 v[4:7], v2, s[8:11], s36 offen offset:0 sc1
  buffer_store_dwordx4 v[4:7], v2, s[8:11], s36 offen offset:1024 sc1
  buffer_store_dwordx4 v[4:7], v2, s[8:11], s36 offen offset:2048 sc1
  buffer_store_dwordx4 v[4:7], v2, s[8:11], s36 offen offset:3072 sc1
  v_mov_b32 v3, 1
  s_nop 0
  v_mov_b32 v4, 196
  s_waitcnt vmcnt(0)
  s_mov_b64 exec, 1
  global_atomic_add v4, v3, s[24:25]
  s_mov_b64 exec, -1
  s_branch L_A_done
L_A_go:
  s_sub_u32 s40, s27, 2
  s_lshl_b32 s40, s40, 5
  s_add_u32 s40, s40, s28
  s_mov_b32 s12, s86
  s_and_b32 s13, s87, 0xffff
  s_mov_b32 s14, 4194304
  s_mov_b32 s15, 0x20000
  s_lshl_b32 s36, s40, 2
  s_add_u32 s36, s36, s26
  s_mul_i32 s36, s36, 5504
  v_lshlrev_b32 v2, 7, v0
  s_bfm_b64 exec, 43, 0
  buffer_load_dword v120, v2, s[12:15], s36 offen
  s_mov_b64 exec, -1
  s_cmp_ge_u32 s40, 186
  s_cbranch_scc1 L_A_done
  s_mul_i32 s42, s40, 0x5556
  s_lshr_b32 s42, s42, 16
  s_mul_i32 s37, s42, 3
  s_sub_u32 s43, s40, s37
  s_lshr_b32 s41, s42, 4
  s_and_b32 s42, s42, 15
  s_mov_b32 s44, 3
  s_cmp_eq_u32 s43, 0
  s_cselect_b32 s54, 22, 21
  s_lshl_b32 s51, s43, 15
  s_lshl_b32 s52, s44, 15
  s_cmp_eq_u32 s41, 3
  s_cbranch_scc1 L_A_setf
  s_cmp_eq_u32 s41, 0
  s_cselect_b32 s66, s82, s80
  s_cselect_b32 s67, s83, s81
  s_cmp_eq_u32 s41, 1
  s_cselect_b32 s66, s84, s66
  s_cselect_b32 s67, s85, s67
  s_lshl_b32 s36, s42, 9
  s_lshl_b32 s37, s26, 7
  s_add_u32 s36, s36, s37
  s_add_u32 s66, s66, s36
  s_addc_u32 s67, s67, 0
  s_sub_u32 s37, 4194304, s36
  s_mov_b32 s12, s66
  s_and_b32 s13, s67, 0xffff
  s_mov_b32 s14, s37
  s_mov_b32 s15, 0x20000
  s_add_u32 s66, s66, 64
  s_addc_u32 s67, s67, 0
  s_sub_u32 s37, s37, 64
  s_mov_b32 s16, s66
  s_and_b32 s17, s67, 0xffff
  s_mov_b32 s18, s37
  s_mov_b32 s19, 0x20000
  s_mov_b32 s45, 8192
  s_lshr_b32 s36, s26, 1
  s_lshl_b32 s37, s42, 1
  s_add_u32 s36, s36, s37
  s_and_b32 s37, s26, 1
  s_lshl_b32 s50, s36, 8
  s_lshl_b32 s38, s41, 6
  s_add_u32 s50, s50, s38
  s_lshl_b32 s38, s37, 5
  s_add_u32 s50, s50, s38
  s_lshl_b32 s38, s43, 3
  s_add_u32 s50, s50, s38
  s_add_u32 s50, s50, 85983232
  s_lshl_b32 s38, s43, 5
  s_add_u32 s38, s38, s36
  s_cmp_eq_u32 s41, 2
  s_cselect_b32 s39, 13, 14
  s_lshl_b32 s47, s38, s39
  s_lshl_b32 s49, s44, 5
  s_lshl_b32 s49, s49, s39
  s_cmp_eq_u32 s41, 2
  s_cselect_b32 s38, 33554432, 0
  s_add_u32 s47, s47, s38
  s_cmp_eq_u32 s41, 1
  s_cselect_b32 s38, 12, 11
  s_lshl_b32 s38, s37, s38
  s_add_u32 s47, s47, s38
  s_cmp_eq_u32 s41, 1
  s_cselect_b32 s38, 8192, 0
  s_add_u32 s47, s47, s38
  s_mov_b32 s59, 4096
  s_lshl_b32 s38, s36, 12
  s_lshl_b32 s39, s37, 11
  s_add_u32 s72, s38, s39
  s_cmp_eq_u32 s41, 1
  s_cselect_b32 s38, 17, 18
  s_lshl_b32 s39, s43, s38
  s_add_u32 s72, s72, s39
  s_lshl_b32 s73, s44, s38
  s_lshl_b32 s39, s41, 16
  s_add_u32 s39, s39, 50331648
  s_cmp_eq_u32 s41, 1
  s_cselect_b32 s39, 75497472, s39
  s_add_u32 s72, s72, s39
  s_branch L_A_set_done
L_A_setf:
  s_lshl_b32 s38, s42, 2
  s_add_u32 s38, s38, s26
  s_lshl_b32 s36, s38, 6
  s_sub_u32 s37, 1835008, s36
  s_add_u32 s66, s68, s36
  s_addc_u32 s67, s69, 0
  s_mov_b32 s12, s66
  s_and_b32 s13, s67, 0xffff
  s_mov_b32 s14, s37
  s_mov_b32 s15, 0x20000
  s_add_u32 s66, s70, s36
  s_addc_u32 s67, s71, 0
  s_mov_b32 s16, s66
  s_and_b32 s17, s67, 0xffff
  s_mov_b32 s18, s37
  s_mov_b32 s19, 0x20000
  s_mov_b32 s45, 3584
  s_lshl_b32 s50, s43, 9
  s_lshl_b32 s36, s38, 3
  s_add_u32 s50, s50, s36
  s_add_u32 s50, s50, 85999616
  s_mul_i32 s47, s43, 114688
  s_lshl_b32 s36, s38, 10
  s_add_u32 s47, s47, s36
  s_add_u32 s47, s47, 67108864
  s_mov_b32 s49, 344064
  s_mov_b32 s59, 57344
L_A_set_done:
  s_lshl_b32 s46, s45, 4
  v_lshrrev_b32 v5, 2, v0
  v_mul_lo_u32 v2, v5, s45
  v_lshrrev_b32 v5, 4, v0
  v_lshrrev_b32 v6, 5, v0
  v_xor_b32 v5, v5, v6
  v_and_b32 v5, 1, v5
  v_lshlrev_b32 v5, 1, v5
  v_and_b32 v6, 3, v0
  v_xor_b32 v5, v5, v6
  v_lshl_add_u32 v2, v5, 4, v2
  s_mul_i32 s36, s26, 40960
  v_lshrrev_b32 v5, 4, v0
  v_bfe_u32 v6, v0, 2, 2
  v_lshl_add_u32 v6, v5, 3, v6
  v_and_b32 v5, 1, v5
  v_lshlrev_b32 v3, 6, v6
  v_lshl_add_u32 v3, v5, 5, v3
  v_and_b32 v5, 3, v0
  v_lshl_add_u32 v3, v5, 3, v3
  v_add_u32 v3, s36, v3
  v_xor_b32 v4, 32, v3
  s_mul_i32 s57, s26, 40960
  s_mov_b32 s60, 0
  s_lshl_b32 s60, s60, 3
  s_mul_i32 s60, s60, s46
  s_mov_b32 s61, 1
  s_lshl_b32 s61, s61, 3
  s_mul_i32 s61, s61, s46
  s_mov_b32 s62, 2
  s_lshl_b32 s62, s62, 3
  s_mul_i32 s62, s62, s46
  s_mov_b32 s63, 3
  s_lshl_b32 s63, s63, 3
  s_mul_i32 s63, s63, s46
  s_add_u32 m0, s57, 0
  s_mul_i32 s58, s46, 0
  s_add_u32 s58, s58, s60
  buffer_load_dwordx4 v2, s[12:15], s58 offen  lds
  s_add_u32 m0, s57, 1024
  s_mul_i32 s58, s46, 1
  s_add_u32 s58, s58, s60
  buffer_load_dwordx4 v2, s[12:15], s58 offen  lds
  s_add_u32 m0, s57, 2048
  s_mul_i32 s58, s46, 2
  s_add_u32 s58, s58, s60
  buffer_load_dwordx4 v2, s[12:15], s58 offen  lds
  s_add_u32 m0, s57, 3072
  s_mul_i32 s58, s46, 3
  s_add_u32 s58, s58, s60
  buffer_load_dwordx4 v2, s[12:15], s58 offen  lds
  s_add_u32 m0, s57, 4096
  s_mul_i32 s58, s46, 4
  s_add_u32 s58, s58, s60
  buffer_load_dwordx4 v2, s[12:15], s58 offen  lds
  s_add_u32 m0, s57, 5120
  s_mul_i32 s58, s46, 5
  s_add_u32 s58, s58, s60
  buffer_load_dwordx4 v2, s[12:15], s58 offen  lds
  s_add_u32 m0, s57, 6144
  s_mul_i32 s58, s46, 6
  s_add_u32 s58, s58, s60
  buffer_load_dwordx4 v2, s[12:15], s58 offen  lds
  s_add_u32 m0, s57, 7168
  s_mul_i32 s58, s46, 7
  s_add_u32 s58, s58, s60
  buffer_load_dwordx4 v2, s[12:15], s58 offen  lds
  s_add_u32 m0, s57, 8192
  s_mul_i32 s58, s46, 0
  s_add_u32 s58, s58, s60
  buffer_load_dwordx4 v2, s[16:19], s58 offen  lds
  s_add_u32 m0, s57, 9216
  s_mul_i32 s58, s46, 1
  s_add_u32 s58, s58, s60
  buffer_load_dwordx4 v2, s[16:19], s58 offen  lds
  s_add_u32 m0, s57, 10240
  s_mul_i32 s58, s46, 2
  s_add_u32 s58, s58, s60
  buffer_load_dwordx4 v2, s[16:19], s58 offen  lds
  s_add_u32 m0, s57, 11264
  s_mul_i32 s58, s46, 3
  s_add_u32 s58, s58, s60
  buffer_load_dwordx4 v2, s[16:19], s58 offen  lds
  s_add_u32 m0, s57, 12288
  s_mul_i32 s58, s46, 4
  s_add_u32 s58, s58, s60
  buffer_load_dwordx4 v2, s[16:19], s58 offen  lds
  s_add_u32 m0, s57, 13312
  s_mul_i32 s58, s46, 5
  s_add_u32 s58, s58, s60
  buffer_load_dwordx4 v2, s[16:19], s58 offen  lds
  s_add_u32 m0, s57, 14336
  s_mul_i32 s58, s46, 6
  s_add_u32 s58, s58, s60
  buffer_load_dwordx4 v2, s[16:19], s58 offen  lds
  s_add_u32 m0, s57, 15360
  s_mul_i32 s58, s46, 7
  s_add_u32 s58, s58, s60
  buffer_load_dwordx4 v2, s[16:19], s58 offen  lds
  s_add_u32 m0, s57, 16384
  s_mul_i32 s58, s46, 0
  s_add_u32 s58, s58, s61
  buffer_load_dwordx4 v2, s[12:15], s58 offen  lds
  s_add_u32 m0, s57, 17408
  s_mul_i32 s58, s46, 1
  s_add_u32 s58, s58, s61
  buffer_load_dwordx4 v2, s[12:15], s58 offen  lds
  s_add_u32 m0, s57, 18432
  s_mul_i32 s58, s46, 2
  s_add_u32 s58, s58, s61
  buffer_load_dwordx4 v2, s[12:15], s58 offen  lds
  s_add_u32 m0, s57, 19456
  s_mul_i32 s58, s46, 3
  s_add_u32 s58, s58, s61
  buffer_load_dwordx4 v2, s[12:15], s58 offen  lds
  s_add_u32 m0, s57, 20480
  s_mul_i32 s58, s46, 4
  s_add_u32 s58, s58, s61
  buffer_load_dwordx4 v2, s[12:15], s58 offen  lds
  s_add_u32 m0, s57, 21504
  s_mul_i32 s58, s46, 5
  s_add_u32 s58, s58, s61
  buffer_load_dwordx4 v2, s[12:15], s58 offen  lds
  s_add_u32 m0, s57, 22528
  s_mul_i32 s58, s46, 6
  s_add_u32 s58, s58, s61
  buffer_load_dwordx4 v2, s[12:15], s58 offen  lds
  s_add_u32 m0, s57, 23552
  s_mul_i32 s58, s46, 7
  s_add_u32 s58, s58, s61
  buffer_load_dwordx4 v2, s[12:15], s58 offen  lds
  s_add_u32 m0, s57, 24576
  s_mul_i32 s58, s46, 0
  s_add_u32 s58, s58, s61
  buffer_load_dwordx4 v2, s[16:19], s58 offen  lds
  s_add_u32 m0, s57, 25600
  s_mul_i32 s58, s46, 1
  s_add_u32 s58, s58, s61
  buffer_load_dwordx4 v2, s[16:19], s58 offen  lds
  s_add_u32 m0, s57, 26624
  s_mul_i32 s58, s46, 2
  s_add_u32 s58, s58, s61
  buffer_load_dwordx4 v2, s[16:19], s58 offen  lds
  s_add_u32 m0, s57, 27648
  s_mul_i32 s58, s46, 3
  s_add_u32 s58, s58, s61
  buffer_load_dwordx4 v2, s[16:19], s58 offen  lds
  s_add_u32 m0, s57, 28672
  s_mul_i32 s58, s46, 4
  s_add_u32 s58, s58, s61
  buffer_load_dwordx4 v2, s[16:19], s58 offen  lds
  s_add_u32 m0, s57, 29696
  s_mul_i32 s58, s46, 5
  s_add_u32 s58, s58, s61
  buffer_load_dwordx4 v2, s[16:19], s58 offen  lds
  s_add_u32 m0, s57, 30720
  s_mul_i32 s58, s46, 6
  s_add_u32 s58, s58, s61
  buffer_load_dwordx4 v2, s[16:19], s58 offen  lds
  s_add_u32 m0, s57, 31744
  s_mul_i32 s58, s46, 7
  s_add_u32 s58, s58, s61
  buffer_load_dwordx4 v2, s[16:19], s58 offen  lds
  s_add_u32 m0, s57, 32768
  s_mul_i32 s58, s46, 0
  s_add_u32 s58, s58, s62
  buffer_load_dwordx4 v2, s[12:15], s58 offen  lds
  s_add_u32 m0, s57, 33792
  s_mul_i32 s58, s46, 1
  s_add_u32 s58, s58, s62
  buffer_load_dwordx4 v2, s[12:15], s58 offen  lds
  s_add_u32 m0, s57, 34816
  s_mul_i32 s58, s46, 2
  s_add_u32 s58, s58, s62
  buffer_load_dwordx4 v2, s[12:15], s58 offen  lds
  s_add_u32 m0, s57, 35840
  s_mul_i32 s58, s46, 3
  s_add_u32 s58, s58, s62
  buffer_load_dwordx4 v2, s[12:15], s58 offen  lds
  s_add_u32 m0, s57, 36864
  s_mul_i32 s58, s46, 4
  s_add_u32 s58, s58, s62
  buffer_load_dwordx4 v2, s[12:15], s58 offen  lds
  s_add_u32 m0, s57, 37888
  s_mul_i32 s58, s46, 5
  s_add_u32 s58, s58, s62
  buffer_load_dwordx4 v2, s[12:15], s58 offen  lds
  s_add_u32 m0, s57, 38912
  s_mul_i32 s58, s46, 6
  s_add_u32 s58, s58, s62
  buffer_load_dwordx4 v2, s[12:15], s58 offen  lds
  s_add_u32 m0, s57, 39936
  s_mul_i32 s58, s46, 7
  s_add_u32 s58, s58, s62
  buffer_load_dwordx4 v2, s[12:15], s58 offen  lds
  s_waitcnt vmcnt(32)
  ds_read_b64_tr_b16 a[0:1], v3 offset:0
  ds_read_b64_tr_b16 a[2:3], v4 offset:256
  ds_read_b64_tr_b16 a[64:65], v4 offset:0
  ds_read_b64_tr_b16 a[66:67], v3 offset:256
  ds_read_b64_tr_b16 a[4:5], v3 offset:2048
  ds_read_b64_tr_b16 a[6:7], v4 offset:2304
  ds_read_b64_tr_b16 a[68:69], v4 offset:2048
  ds_read_b64_tr_b16 a[70:71], v3 offset:2304
  ds_read_b64_tr_b16 a[8:9], v3 offset:4096
  ds_read_b64_tr_b16 a[10:11], v4 offset:4352
  ds_read_b64_tr_b16 a[72:73], v4 offset:4096
  ds_read_b64_tr_b16 a[74:75], v3 offset:4352
  ds_read_b64_tr_b16 a[12:13], v3 offset:6144
  ds_read_b64_tr_b16 a[14:15], v4 offset:6400
  ds_read_b64_tr_b16 a[76:77], v4 offset:6144
  ds_read_b64_tr_b16 a[78:79], v3 offset:6400
  s_waitcnt lgkmcnt(0)
  s_add_u32 m0, s57, 0
  s_mul_i32 s58, s46, 0
  s_add_u32 s58, s58, s62
  buffer_load_dwordx4 v2, s[16:19], s58 offen  lds
  s_add_u32 m0, s57, 1024
  s_mul_i32 s58, s46, 1
  s_add_u32 s58, s58, s62
  buffer_load_dwordx4 v2, s[16:19], s58 offen  lds
  s_add_u32 m0, s57, 2048
  s_mul_i32 s58, s46, 2
  s_add_u32 s58, s58, s62
  buffer_load_dwordx4 v2, s[16:19], s58 offen  lds
  s_add_u32 m0, s57, 3072
  s_mul_i32 s58, s46, 3
  s_add_u32 s58, s58, s62
  buffer_load_dwordx4 v2, s[16:19], s58 offen  lds
  s_add_u32 m0, s57, 4096
  s_mul_i32 s58, s46, 4
  s_add_u32 s58, s58, s62
  buffer_load_dwordx4 v2, s[16:19], s58 offen  lds
  s_add_u32 m0, s57, 5120
  s_mul_i32 s58, s46, 5
  s_add_u32 s58, s58, s62
  buffer_load_dwordx4 v2, s[16:19], s58 offen  lds
  s_add_u32 m0, s57, 6144
  s_mul_i32 s58, s46, 6
  s_add_u32 s58, s58, s62
  buffer_load_dwordx4 v2, s[16:19], s58 offen  lds
  s_add_u32 m0, s57, 7168
  s_mul_i32 s58, s46, 7
  s_add_u32 s58, s58, s62
  buffer_load_dwordx4 v2, s[16:19], s58 offen  lds
  s_waitcnt vmcnt(32)
  ds_read_b64_tr_b16 a[128:129], v3 offset:8192
  ds_read_b64_tr_b16 a[130:131], v4 offset:8448
  ds_read_b64_tr_b16 a[192:193], v4 offset:8192
  ds_read_b64_tr_b16 a[194:195], v3 offset:8448
  ds_read_b64_tr_b16 a[132:133], v3 offset:10240
  ds_read_b64_tr_b16 a[134:135], v4 offset:10496
  ds_read_b64_tr_b16 a[196:197], v4 offset:10240
  ds_read_b64_tr_b16 a[198:199], v3 offset:10496
  ds_read_b64_tr_b16 a[136:137], v3 offset:12288
  ds_read_b64_tr_b16 a[138:139], v4 offset:12544
  ds_read_b64_tr_b16 a[200:201], v4 offset:12288
  ds_read_b64_tr_b16 a[202:203], v3 offset:12544
  ds_read_b64_tr_b16 a[140:141], v3 offset:14336
  ds_read_b64_tr_b16 a[142:143], v4 offset:14592
  ds_read_b64_tr_b16 a[204:205], v4 offset:14336
  ds_read_b64_tr_b16 a[206:207], v3 offset:14592
  s_waitcnt lgkmcnt(0)
  s_add_u32 m0, s57, 8192
  s_mul_i32 s58, s46, 0
  s_add_u32 s58, s58, s63
  buffer_load_dwordx4 v2, s[12:15], s58 offen  lds
  s_add_u32 m0, s57, 9216
  s_mul_i32 s58, s46, 1
  s_add_u32 s58, s58, s63
  buffer_load_dwordx4 v2, s[12:15], s58 offen  lds
  s_add_u32 m0, s57, 10240
  s_mul_i32 s58, s46, 2
  s_add_u32 s58, s58, s63
  buffer_load_dwordx4 v2, s[12:15], s58 offen  lds
  s_add_u32 m0, s57, 11264
  s_mul_i32 s58, s46, 3
  s_add_u32 s58, s58, s63
  buffer_load_dwordx4 v2, s[12:15], s58 offen  lds
  s_add_u32 m0, s57, 12288
  s_mul_i32 s58, s46, 4
  s_add_u32 s58, s58, s63
  buffer_load_dwordx4 v2, s[12:15], s58 offen  lds
  s_add_u32 m0, s57, 13312
  s_mul_i32 s58, s46, 5
  s_add_u32 s58, s58, s63
  buffer_load_dwordx4 v2, s[12:15], s58 offen  lds
  s_add_u32 m0, s57, 14336
  s_mul_i32 s58, s46, 6
  s_add_u32 s58, s58, s63
  buffer_load_dwordx4 v2, s[12:15], s58 offen  lds
  s_add_u32 m0, s57, 15360
  s_mul_i32 s58, s46, 7
  s_add_u32 s58, s58, s63
  buffer_load_dwordx4 v2, s[12:15], s58 offen  lds
  s_waitcnt vmcnt(32)
  ds_read_b64_tr_b16 a[16:17], v3 offset:16384
  ds_read_b64_tr_b16 a[18:19], v4 offset:16640
  ds_read_b64_tr_b16 a[80:81], v4 offset:16384
  ds_read_b64_tr_b16 a[82:83], v3 offset:16640
  ds_read_b64_tr_b16 a[20:21], v3 offset:18432
  ds_read_b64_tr_b16 a[22:23], v4 offset:18688
  ds_read_b64_tr_b16 a[84:85], v4 offset:18432
  ds_read_b64_tr_b16 a[86:87], v3 offset:18688
  ds_read_b64_tr_b16 a[24:25], v3 offset:20480
  ds_read_b64_tr_b16 a[26:27], v4 offset:20736
  ds_read_b64_tr_b16 a[88:89], v4 offset:20480
  ds_read_b64_tr_b16 a[90:91], v3 offset:20736
  ds_read_b64_tr_b16 a[28:29], v3 offset:22528
  ds_read_b64_tr_b16 a[30:31], v4 offset:22784
  ds_read_b64_tr_b16 a[92:93], v4 offset:22528
  ds_read_b64_tr_b16 a[94:95], v3 offset:22784
  s_waitcnt lgkmcnt(0)
  s_add_u32 m0, s57, 16384
  s_mul_i32 s58, s46, 0
  s_add_u32 s58, s58, s63
  buffer_load_dwordx4 v2, s[16:19], s58 offen  lds
  s_add_u32 m0, s57, 17408
  s_mul_i32 s58, s46, 1
  s_add_u32 s58, s58, s63
  buffer_load_dwordx4 v2, s[16:19], s58 offen  lds
  s_add_u32 m0, s57, 18432
  s_mul_i32 s58, s46, 2
  s_add_u32 s58, s58, s63
  buffer_load_dwordx4 v2, s[16:19], s58 offen  lds
  s_add_u32 m0, s57, 19456
  s_mul_i32 s58, s46, 3
  s_add_u32 s58, s58, s63
  buffer_load_dwordx4 v2, s[16:19], s58 offen  lds
  s_add_u32 m0, s57, 20480
  s_mul_i32 s58, s46, 4
  s_add_u32 s58, s58, s63
  buffer_load_dwordx4 v2, s[16:19], s58 offen  lds
  s_add_u32 m0, s57, 21504
  s_mul_i32 s58, s46, 5
  s_add_u32 s58, s58, s63
  buffer_load_dwordx4 v2, s[16:19], s58 offen  lds
  s_add_u32 m0, s57, 22528
  s_mul_i32 s58, s46, 6
  s_add_u32 s58, s58, s63
  buffer_load_dwordx4 v2, s[16:19], s58 offen  lds
  s_add_u32 m0, s57, 23552
  s_mul_i32 s58, s46, 7
  s_add_u32 s58, s58, s63
  buffer_load_dwordx4 v2, s[16:19], s58 offen  lds
  s_waitcnt vmcnt(32)
  ds_read_b64_tr_b16 a[144:145], v3 offset:24576
  ds_read_b64_tr_b16 a[146:147], v4 offset:24832
  ds_read_b64_tr_b16 a[208:209], v4 offset:24576
  ds_read_b64_tr_b16 a[210:211], v3 offset:24832
  ds_read_b64_tr_b16 a[148:149], v3 offset:26624
  ds_read_b64_tr_b16 a[150:151], v4 offset:26880
  ds_read_b64_tr_b16 a[212:213], v4 offset:26624
  ds_read_b64_tr_b16 a[214:215], v3 offset:26880
  ds_read_b64_tr_b16 a[152:153], v3 offset:28672
  ds_read_b64_tr_b16 a[154:155], v4 offset:28928
  ds_read_b64_tr_b16 a[216:217], v4 offset:28672
  ds_read_b64_tr_b16 a[218:219], v3 offset:28928
  ds_read_b64_tr_b16 a[156:157], v3 offset:30720
  ds_read_b64_tr_b16 a[158:159], v4 offset:30976
  ds_read_b64_tr_b16 a[220:221], v4 offset:30720
  ds_read_b64_tr_b16 a[222:223], v3 offset:30976
  s_waitcnt vmcnt(24)
  ds_read_b64_tr_b16 a[32:33], v3 offset:32768
  ds_read_b64_tr_b16 a[34:35], v4 offset:33024
  ds_read_b64_tr_b16 a[96:97], v4 offset:32768
  ds_read_b64_tr_b16 a[98:99], v3 offset:33024
  ds_read_b64_tr_b16 a[36:37], v3 offset:34816
  ds_read_b64_tr_b16 a[38:39], v4 offset:35072
  ds_read_b64_tr_b16 a[100:101], v4 offset:34816
  ds_read_b64_tr_b16 a[102:103], v3 offset:35072
  ds_read_b64_tr_b16 a[40:41], v3 offset:36864
  ds_read_b64_tr_b16 a[42:43], v4 offset:37120
  ds_read_b64_tr_b16 a[104:105], v4 offset:36864
  ds_read_b64_tr_b16 a[106:107], v3 offset:37120
  ds_read_b64_tr_b16 a[44:45], v3 offset:38912
  ds_read_b64_tr_b16 a[46:47], v4 offset:39168
  ds_read_b64_tr_b16 a[108:109], v4 offset:38912
  ds_read_b64_tr_b16 a[110:111], v3 offset:39168
  s_waitcnt vmcnt(16)
  ds_read_b64_tr_b16 a[160:161], v3 offset:0
  ds_read_b64_tr_b16 a[162:163], v4 offset:256
  ds_read_b64_tr_b16 a[224:225], v4 offset:0
  ds_read_b64_tr_b16 a[226:227], v3 offset:256
  ds_read_b64_tr_b16 a[164:165], v3 offset:2048
  ds_read_b64_tr_b16 a[166:167], v4 offset:2304
  ds_read_b64_tr_b16 a[228:229], v4 offset:2048
  ds_read_b64_tr_b16 a[230:231], v3 offset:2304
  ds_read_b64_tr_b16 a[168:169], v3 offset:4096
  ds_read_b64_tr_b16 a[170:171], v4 offset:4352
  ds_read_b64_tr_b16 a[232:233], v4 offset:4096
  ds_read_b64_tr_b16 a[234:235], v3 offset:4352
  ds_read_b64_tr_b16 a[172:173], v3 offset:6144
  ds_read_b64_tr_b16 a[174:175], v4 offset:6400
  ds_read_b64_tr_b16 a[236:237], v4 offset:6144
  ds_read_b64_tr_b16 a[238:239], v3 offset:6400
  s_waitcnt vmcnt(8)
  ds_read_b64_tr_b16 a[48:49], v3 offset:8192
  ds_read_b64_tr_b16 a[50:51], v4 offset:8448
  ds_read_b64_tr_b16 a[112:113], v4 offset:8192
  ds_read_b64_tr_b16 a[114:115], v3 offset:8448
  ds_read_b64_tr_b16 a[52:53], v3 offset:10240
  ds_read_b64_tr_b16 a[54:55], v4 offset:10496
  ds_read_b64_tr_b16 a[116:117], v4 offset:10240
  ds_read_b64_tr_b16 a[118:119], v3 offset:10496
  ds_read_b64_tr_b16 a[56:57], v3 offset:12288
  ds_read_b64_tr_b16 a[58:59], v4 offset:12544
  ds_read_b64_tr_b16 a[120:121], v4 offset:12288
  ds_read_b64_tr_b16 a[122:123], v3 offset:12544
  ds_read_b64_tr_b16 a[60:61], v3 offset:14336
  ds_read_b64_tr_b16 a[62:63], v4 offset:14592
  ds_read_b64_tr_b16 a[124:125], v4 offset:14336
  ds_read_b64_tr_b16 a[126:127], v3 offset:14592
  s_waitcnt vmcnt(0)
  ds_read_b64_tr_b16 a[176:177], v3 offset:16384
  ds_read_b64_tr_b16 a[178:179], v4 offset:16640
  ds_read_b64_tr_b16 a[240:241], v4 offset:16384
  ds_read_b64_tr_b16 a[242:243], v3 offset:16640
  ds_read_b64_tr_b16 a[180:181], v3 offset:18432
  ds_read_b64_tr_b16 a[182:183], v4 offset:18688
  ds_read_b64_tr_b16 a[244:245], v4 offset:18432
  ds_read_b64_tr_b16 a[246:247], v3 offset:18688
  ds_read_b64_tr_b16 a[184:185], v3 offset:20480
  ds_read_b64_tr_b16 a[186:187], v4 offset:20736
  ds_read_b64_tr_b16 a[248:249], v4 offset:20480
  ds_read_b64_tr_b16 a[250:251], v3 offset:20736
  ds_read_b64_tr_b16 a[188:189], v3 offset:22528
  ds_read_b64_tr_b16 a[190:191], v4 offset:22784
  ds_read_b64_tr_b16 a[252:253], v4 offset:22528
  ds_read_b64_tr_b16 a[254:255], v3 offset:22784
  s_waitcnt lgkmcnt(0)
  v_mov_b32 v10, 208
L_nonce_1:
  s_sub_u32 s100, s100, 1
  s_cbranch_scc1 L_end
  global_load_dwordx2 v[8:9], v10, s[24:25] sc1
  s_waitcnt vmcnt(0)
L_nonce_2:
  v_readfirstlane_b32 s30, v8
  v_readfirstlane_b32 s31, v9
  s_mul_i32 s36, s30, 0x9E3779B1
  s_or_b32 s36, s36, 1
  s_cmp_eq_u32 s36, s31
  s_cbranch_scc0 L_nonce_1
  s_barrier
  s_lshl_b32 s36, s26, 3
  s_add_u32 s36, s36, 0
  s_and_b32 s36, s36, 15
  v_xor_b32 v8, s36, v0
  v_lshlrev_b32 v8, 4, v8
  s_lshl_b32 s36, s26, 13
  s_add_u32 s36, s36, 0
  v_add_u32 v8, s36, v8
  s_lshl_b32 s36, s26, 3
  s_add_u32 s36, s36, 1
  s_and_b32 s36, s36, 15
  v_xor_b32 v9, s36, v0
  v_lshlrev_b32 v9, 4, v9
  s_lshl_b32 s36, s26, 13
  s_add_u32 s36, s36, 0
  v_add_u32 v9, s36, v9
  s_lshl_b32 s36, s26, 3
  s_add_u32 s36, s36, 2
  s_and_b32 s36, s36, 15
  v_xor_b32 v10, s36, v0
  v_lshlrev_b32 v10, 4, v10
  s_lshl_b32 s36, s26, 13
  s_add_u32 s36, s36, 0
  v_add_u32 v10, s36, v10
  s_lshl_b32 s36, s26, 3
  s_add_u32 s36, s36, 3
  s_and_b32 s36, s36, 15
  v_xor_b32 v11, s36, v0
  v_lshlrev_b32 v11, 4, v11
  s_lshl_b32 s36, s26, 13
  s_add_u32 s36, s36, 0
  v_add_u32 v11, s36, v11
  s_lshl_b32 s36, s26, 3
  s_add_u32 s36, s36, 4
  s_and_b32 s36, s36, 15
  v_xor_b32 v12, s36, v0
  v_lshlrev_b32 v12, 4, v12
  s_lshl_b32 s36, s26, 13
  s_add_u32 s36, s36, 4096
  v_add_u32 v12, s36, v12
  s_lshl_b32 s36, s26, 3
  s_add_u32 s36, s36, 5
  s_and_b32 s36, s36, 15
  v_xor_b32 v13, s36, v0
  v_lshlrev_b32 v13, 4, v13
  s_lshl_b32 s36, s26, 13
  s_add_u32 s36, s36, 4096
  v_add_u32 v13, s36, v13
  s_lshl_b32 s36, s26, 3
  s_add_u32 s36, s36, 6
  s_and_b32 s36, s36, 15
  v_xor_b32 v14, s36, v0
  v_lshlrev_b32 v14, 4, v14
  s_lshl_b32 s36, s26, 13
  s_add_u32 s36, s36, 4096
  v_add_u32 v14, s36, v14
  s_lshl_b32 s36, s26, 3
  s_add_u32 s36, s36, 7
  s_and_b32 s36, s36, 15
  v_xor_b32 v15, s36, v0
  v_lshlrev_b32 v15, 4, v15
  s_lshl_b32 s36, s26, 13
  s_add_u32 s36, s36, 4096
  v_add_u32 v15, s36, v15
  v_and_b32 v5, 15, v0
  v_lshrrev_b32 v6, 4, v0
  v_add_u32 v7, 0, v6
  v_xor_b32 v7, v7, v5
  v_lshlrev_b32 v7, 4, v7
  v_lshl_add_u32 v16, v5, 10, v7
  v_add_u32 v7, 4, v6
  v_xor_b32 v7, v7, v5
  v_lshlrev_b32 v7, 4, v7
  v_lshl_add_u32 v17, v5, 10, v7
  v_add_u32 v7, 8, v6
  v_xor_b32 v7, v7, v5
  v_lshlrev_b32 v7, 4, v7
  v_lshl_add_u32 v18, v5, 10, v7
  v_add_u32 v7, 12, v6
  v_xor_b32 v7, v7, v5
  v_lshlrev_b32 v7, 4, v7
  v_lshl_add_u32 v19, v5, 10, v7
  v_lshlrev_b32 v24, 4, v0
  v_mov_b32 v25, 0
  v_mov_b64 v[28:29], -1
  v_mov_b64 v[30:31], -1
  v_mov_b32 v27, s31
  s_lshl_b32 s57, s26, 13
  s_mov_b32 s56, 0
  s_mov_b32 s55, 0
  s_mov_b32 s53, 0
  s_add_u32 s58, s57, s56
  s_add_u32 m0, s58, 0
  s_nop 0
  buffer_load_dwordx4 v8, s[4:7], s51 offen offset:0 lds
  buffer_load_dwordx4 v9, s[4:7], s51 offen offset:1024 lds
  buffer_load_dwordx4 v10, s[4:7], s51 offen offset:2048 lds
  buffer_load_dwordx4 v11, s[4:7], s51 offen offset:3072 lds
  s_add_u32 s58, s57, s56
  s_add_u32 m0, s58, 4096
  s_nop 0
  buffer_load_dwordx4 v12, s[4:7], s51 offen offset:0 lds
  buffer_load_dwordx4 v13, s[4:7], s51 offen offset:1024 lds
  buffer_load_dwordx4 v14, s[4:7], s51 offen offset:2048 lds
  buffer_load_dwordx4 v15, s[4:7], s51 offen offset:3072 lds
  s_add_u32 s51, s51, s52
  s_add_u32 s56, s56, 32768
  s_cmp_eq_u32 s56, 98304
  s_cselect_b32 s56, 0, s56
  s_add_u32 s58, s57, s56
  s_add_u32 m0, s58, 0
  s_nop 0
  buffer_load_dwordx4 v8, s[4:7], s51 offen offset:0 lds
  buffer_load_dwordx4 v9, s[4:7], s51 offen offset:1024 lds
  buffer_load_dwordx4 v10, s[4:7], s51 offen offset:2048 lds
  buffer_load_dwordx4 v11, s[4:7], s51 offen offset:3072 lds
  s_add_u32 s58, s57, s56
  s_add_u32 m0, s58, 4096
  s_nop 0
  buffer_load_dwordx4 v12, s[4:7], s51 offen offset:0 lds
  buffer_load_dwordx4 v13, s[4:7], s51 offen offset:1024 lds
  buffer_load_dwordx4 v14, s[4:7], s51 offen offset:2048 lds
  buffer_load_dwordx4 v15, s[4:7], s51 offen offset:3072 lds
  s_add_u32 s51, s51, s52
  s_add_u32 s56, s56, 32768
  s_cmp_eq_u32 s56, 98304
  s_cselect_b32 s56, 0, s56
  s_waitcnt vmcnt(8)
  v_add_u32 v20, s55, v16
  v_add_u32 v21, s55, v17
  v_add_u32 v22, s55, v18
  v_add_u32 v23, s55, v19
  s_barrier
  ds_read_b128 v[64:67], v20 offset:0
  ds_read_b128 v[68:71], v20 offset:16384
  ds_read_b128 v[72:75], v21 offset:0
  ds_read_b128 v[76:79], v21 offset:16384
  ds_read_b128 v[80:83], v22 offset:0
  ds_read_b128 v[84:87], v22 offset:16384
  s_cmp_eq_u32 s41, 1
  s_cbranch_scc1 L_A_loopV
  s_cmp_eq_u32 s41, 3
  s_cbranch_scc1 L_A_loopF
L_A_loopK:
  s_waitcnt lgkmcnt(4)
  v_mfma_f32_16x16x32_bf16 v[32:35], a[0:3], v[64:67], 0
  ds_read_b128 v[88:91], v23 offset:0
  v_mfma_f32_16x16x32_bf16 v[40:43], a[64:67], v[64:67], 0
  ds_read_b128 v[92:95], v23 offset:16384
  v_mfma_f32_16x16x32_bf16 v[48:51], a[128:131], v[64:67], 0
  s_add_u32 s58, s57, s56
  v_mfma_f32_16x16x32_bf16 v[56:59], a[192:195], v[64:67], 0
  s_add_u32 m0, s58, 0
  v_mfma_f32_16x16x32_bf16 v[36:39], a[0:3], v[68:71], 0
  buffer_load_dwordx4 v8, s[4:7], s51 offen offset:0 lds
  v_mfma_f32_16x16x32_bf16 v[44:47], a[64:67], v[68:71], 0
  buffer_load_dwordx4 v9, s[4:7], s51 offen offset:1024 lds
  v_mfma_f32_16x16x32_bf16 v[52:55], a[128:131], v[68:71], 0
  buffer_load_dwordx4 v10, s[4:7], s51 offen offset:2048 lds
  v_mfma_f32_16x16x32_bf16 v[60:63], a[192:195], v[68:71], 0
  s_waitcnt lgkmcnt(4)
  v_mfma_f32_16x16x32_bf16 v[32:35], a[4:7], v[72:75], v[32:35]
  ds_read_b128 v[64:67], v20 offset:256
  v_mfma_f32_16x16x32_bf16 v[40:43], a[68:71], v[72:75], v[40:43]
  ds_read_b128 v[68:71], v20 offset:16640
  v_mfma_f32_16x16x32_bf16 v[48:51], a[132:135], v[72:75], v[48:51]
  buffer_load_dwordx4 v11, s[4:7], s51 offen offset:3072 lds
  v_mfma_f32_16x16x32_bf16 v[56:59], a[196:199], v[72:75], v[56:59]
  s_add_u32 s58, s57, s56
  v_mfma_f32_16x16x32_bf16 v[36:39], a[4:7], v[76:79], v[36:39]
  s_add_u32 m0, s58, 4096
  v_mfma_f32_16x16x32_bf16 v[44:47], a[68:71], v[76:79], v[44:47]
  buffer_load_dwordx4 v12, s[4:7], s51 offen offset:0 lds
  v_mfma_f32_16x16x32_bf16 v[52:55], a[132:135], v[76:79], v[52:55]
  buffer_load_dwordx4 v13, s[4:7], s51 offen offset:1024 lds
  v_mfma_f32_16x16x32_bf16 v[60:63], a[196:199], v[76:79], v[60:63]
  s_waitcnt lgkmcnt(4)
  v_mfma_f32_16x16x32_bf16 v[32:35], a[8:11], v[80:83], v[32:35]
  ds_read_b128 v[72:75], v21 offset:256
  v_mfma_f32_16x16x32_bf16 v[40:43], a[72:75], v[80:83], v[40:43]
  ds_read_b128 v[76:79], v21 offset:16640
  v_mfma_f32_16x16x32_bf16 v[48:51], a[136:139], v[80:83], v[48:51]
  buffer_load_dwordx4 v14, s[4:7], s51 offen offset:2048 lds
  v_mfma_f32_16x16x32_bf16 v[56:59], a[200:203], v[80:83], v[56:59]
  buffer_load_dwordx4 v15, s[4:7], s51 offen offset:3072 lds
  v_mfma_f32_16x16x32_bf16 v[36:39], a[8:11], v[84:87], v[36:39]
  s_add_u32 s51, s51, s52
  v_mfma_f32_16x16x32_bf16 v[44:47], a[72:75], v[84:87], v[44:47]
  s_add_u32 s56, s56, 32768
  v_mfma_f32_16x16x32_bf16 v[52:55], a[136:139], v[84:87], v[52:55]
  s_cmp_eq_u32 s56, 98304
  v_mfma_f32_16x16x32_bf16 v[60:63], a[200:203], v[84:87], v[60:63]
  s_waitcnt lgkmcnt(4)
  v_mfma_f32_16x16x32_bf16 v[32:35], a[12:15], v[88:91], v[32:35]
  ds_read_b128 v[80:83], v22 offset:256
  v_mfma_f32_16x16x32_bf16 v[40:43], a[76:79], v[88:91], v[40:43]
  ds_read_b128 v[84:87], v22 offset:16640
  v_mfma_f32_16x16x32_bf16 v[48:51], a[140:143], v[88:91], v[48:51]
  s_cselect_b32 s56, 0, s56
  v_mfma_f32_16x16x32_bf16 v[56:59], a[204:207], v[88:91], v[56:59]
  v_mfma_f32_16x16x32_bf16 v[36:39], a[12:15], v[92:95], v[36:39]
  v_mfma_f32_16x16x32_bf16 v[44:47], a[76:79], v[92:95], v[44:47]
  v_mfma_f32_16x16x32_bf16 v[52:55], a[140:143], v[92:95], v[52:55]
  v_mfma_f32_16x16x32_bf16 v[60:63], a[204:207], v[92:95], v[60:63]
  s_waitcnt lgkmcnt(4)
  v_mfma_f32_16x16x32_bf16 v[32:35], a[16:19], v[64:67], v[32:35]
  ds_read_b128 v[88:91], v23 offset:256
  v_mfma_f32_16x16x32_bf16 v[40:43], a[80:83], v[64:67], v[40:43]
  ds_read_b128 v[92:95], v23 offset:16640
  v_mfma_f32_16x16x32_bf16 v[48:51], a[144:147], v[64:67], v[48:51]
  v_mfma_f32_16x16x32_bf16 v[56:59], a[208:211], v[64:67], v[56:59]
  v_mfma_f32_16x16x32_bf16 v[36:39], a[16:19], v[68:71], v[36:39]
  v_mfma_f32_16x16x32_bf16 v[44:47], a[80:83], v[68:71], v[44:47]
  v_mfma_f32_16x16x32_bf16 v[52:55], a[144:147], v[68:71], v[52:55]
  v_mfma_f32_16x16x32_bf16 v[60:63], a[208:211], v[68:71], v[60:63]
  s_waitcnt lgkmcnt(4)
  v_mfma_f32_16x16x32_bf16 v[32:35], a[20:23], v[72:75], v[32:35]
  ds_read_b128 v[64:67], v20 offset:512
  v_mfma_f32_16x16x32_bf16 v[40:43], a[84:87], v[72:75], v[40:43]
  ds_read_b128 v[68:71], v20 offset:16896
  v_mfma_f32_16x16x32_bf16 v[48:51], a[148:151], v[72:75], v[48:51]
  v_mfma_f32_16x16x32_bf16 v[56:59], a[212:215], v[72:75], v[56:59]
  v_mfma_f32_16x16x32_bf16 v[36:39], a[20:23], v[76:79], v[36:39]
  v_mfma_f32_16x16x32_bf16 v[44:47], a[84:87], v[76:79], v[44:47]
  v_mfma_f32_16x16x32_bf16 v[52:55], a[148:151], v[76:79], v[52:55]
  v_mfma_f32_16x16x32_bf16 v[60:63], a[212:215], v[76:79], v[60:63]
  s_waitcnt lgkmcnt(4)
  v_mfma_f32_16x16x32_bf16 v[32:35], a[24:27], v[80:83], v[32:35]
  ds_read_b128 v[72:75], v21 offset:512
  v_mfma_f32_16x16x32_bf16 v[40:43], a[88:91], v[80:83], v[40:43]
  ds_read_b128 v[76:79], v21 offset:16896
  v_mfma_f32_16x16x32_bf16 v[48:51], a[152:155], v[80:83], v[48:51]
  v_mfma_f32_16x16x32_bf16 v[56:59], a[216:219], v[80:83], v[56:59]
  v_mfma_f32_16x16x32_bf16 v[36:39], a[24:27], v[84:87], v[36:39]
  v_mfma_f32_16x16x32_bf16 v[44:47], a[88:91], v[84:87], v[44:47]
  v_mfma_f32_16x16x32_bf16 v[52:55], a[152:155], v[84:87], v[52:55]
  v_mfma_f32_16x16x32_bf16 v[60:63], a[216:219], v[84:87], v[60:63]
  s_waitcnt lgkmcnt(4)
  v_mfma_f32_16x16x32_bf16 v[32:35], a[28:31], v[88:91], v[32:35]
  ds_read_b128 v[80:83], v22 offset:512
  v_mfma_f32_16x16x32_bf16 v[40:43], a[92:95], v[88:91], v[40:43]
  ds_read_b128 v[84:87], v22 offset:16896
  v_mfma_f32_16x16x32_bf16 v[48:51], a[156:159], v[88:91], v[48:51]
  v_mfma_f32_16x16x32_bf16 v[56:59], a[220:223], v[88:91], v[56:59]
  v_mfma_f32_16x16x32_bf16 v[36:39], a[28:31], v[92:95], v[36:39]
  v_mfma_f32_16x16x32_bf16 v[44:47], a[92:95], v[92:95], v[44:47]
  v_mfma_f32_16x16x32_bf16 v[52:55], a[156:159], v[92:95], v[52:55]
  v_mfma_f32_16x16x32_bf16 v[60:63], a[220:223], v[92:95], v[60:63]
  s_waitcnt lgkmcnt(4)
  v_mfma_f32_16x16x32_bf16 v[32:35], a[32:35], v[64:67], v[32:35]
  ds_read_b128 v[88:91], v23 offset:512
  v_mfma_f32_16x16x32_bf16 v[40:43], a[96:99], v[64:67], v[40:43]
  ds_read_b128 v[92:95], v23 offset:16896
  v_mfma_f32_16x16x32_bf16 v[48:51], a[160:163], v[64:67], v[48:51]
  v_mfma_f32_16x16x32_bf16 v[56:59], a[224:227], v[64:67], v[56:59]
  v_mfma_f32_16x16x32_bf16 v[36:39], a[32:35], v[68:71], v[36:39]
  v_mfma_f32_16x16x32_bf16 v[44:47], a[96:99], v[68:71], v[44:47]
  v_mfma_f32_16x16x32_bf16 v[52:55], a[160:163], v[68:71], v[52:55]
  v_mfma_f32_16x16x32_bf16 v[60:63], a[224:227], v[68:71], v[60:63]
  s_waitcnt lgkmcnt(4)
  v_mfma_f32_16x16x32_bf16 v[32:35], a[36:39], v[72:75], v[32:35]
  ds_read_b128 v[64:67], v20 offset:768
  v_mfma_f32_16x16x32_bf16 v[40:43], a[100:103], v[72:75], v[40:43]
  ds_read_b128 v[68:71], v20 offset:17152
  v_mfma_f32_16x16x32_bf16 v[48:51], a[164:167], v[72:75], v[48:51]
  v_mfma_f32_16x16x32_bf16 v[56:59], a[228:231], v[72:75], v[56:59]
  v_mfma_f32_16x16x32_bf16 v[36:39], a[36:39], v[76:79], v[36:39]
  v_mfma_f32_16x16x32_bf16 v[44:47], a[100:103], v[76:79], v[44:47]
  v_mfma_f32_16x16x32_bf16 v[52:55], a[164:167], v[76:79], v[52:55]
  v_mfma_f32_16x16x32_bf16 v[60:63], a[228:231], v[76:79], v[60:63]
  s_waitcnt lgkmcnt(4)
  v_mfma_f32_16x16x32_bf16 v[32:35], a[40:43], v[80:83], v[32:35]
  ds_read_b128 v[72:75], v21 offset:768
  v_mfma_f32_16x16x32_bf16 v[40:43], a[104:107], v[80:83], v[40:43]
  ds_read_b128 v[76:79], v21 offset:17152
  v_mfma_f32_16x16x32_bf16 v[48:51], a[168:171], v[80:83], v[48:51]
  s_add_u32 s36, s53, s30
  v_mfma_f32_16x16x32_bf16 v[56:59], a[232:235], v[80:83], v[56:59]
  v_mov_b32 v26, s36
  v_mfma_f32_16x16x32_bf16 v[36:39], a[40:43], v[84:87], v[36:39]
  s_waitcnt vmcnt(8)
  s_bitcmp1_b32 0x4116, s53
  v_mfma_f32_16x16x32_bf16 v[44:47], a[104:107], v[84:87], v[44:47]
  s_cbranch_scc0 L_A_nfK
  s_mov_b64 exec, 1
  buffer_store_dwordx2 v[26:27], v25, s[8:11], s50 offen sc1
  s_mov_b64 exec, -1
L_A_nfK:
  v_mfma_f32_16x16x32_bf16 v[52:55], a[168:171], v[84:87], v[52:55]
  v_mfma_f32_16x16x32_bf16 v[60:63], a[232:235], v[84:87], v[60:63]
  s_waitcnt lgkmcnt(4)
  v_mfma_f32_16x16x32_bf16 v[32:35], a[44:47], v[88:91], v[32:35]
  ds_read_b128 v[80:83], v22 offset:768
  v_mfma_f32_16x16x32_bf16 v[40:43], a[108:111], v[88:91], v[40:43]
  ds_read_b128 v[84:87], v22 offset:17152
  v_mfma_f32_16x16x32_bf16 v[48:51], a[172:175], v[88:91], v[48:51]
  v_mfma_f32_16x16x32_bf16 v[56:59], a[236:239], v[88:91], v[56:59]
  v_mfma_f32_16x16x32_bf16 v[36:39], a[44:47], v[92:95], v[36:39]
  v_mfma_f32_16x16x32_bf16 v[44:47], a[108:111], v[92:95], v[44:47]
  v_mfma_f32_16x16x32_bf16 v[52:55], a[172:175], v[92:95], v[52:55]
  v_mfma_f32_16x16x32_bf16 v[60:63], a[236:239], v[92:95], v[60:63]
  s_waitcnt lgkmcnt(4)
  v_mfma_f32_16x16x32_bf16 v[32:35], a[48:51], v[64:67], v[32:35]
  ds_read_b128 v[88:91], v23 offset:768
  v_mfma_f32_16x16x32_bf16 v[40:43], a[112:115], v[64:67], v[40:43]
  ds_read_b128 v[92:95], v23 offset:17152
  v_mfma_f32_16x16x32_bf16 v[48:51], a[176:179], v[64:67], v[48:51]
  v_mfma_f32_16x16x32_bf16 v[56:59], a[240:243], v[64:67], v[56:59]
  v_mfma_f32_16x16x32_bf16 v[36:39], a[48:51], v[68:71], v[36:39]
  v_mfma_f32_16x16x32_bf16 v[44:47], a[112:115], v[68:71], v[44:47]
  v_mfma_f32_16x16x32_bf16 v[52:55], a[176:179], v[68:71], v[52:55]
  v_mfma_f32_16x16x32_bf16 v[60:63], a[240:243], v[68:71], v[60:63]
  s_waitcnt lgkmcnt(4)
  v_mfma_f32_16x16x32_bf16 v[32:35], a[52:55], v[72:75], v[32:35]
  v_mfma_f32_16x16x32_bf16 v[40:43], a[116:119], v[72:75], v[40:43]
  v_mfma_f32_16x16x32_bf16 v[48:51], a[180:183], v[72:75], v[48:51]
  buffer_store_dwordx4 v[28:31], v24, s[8:11], s72 offen sc1
  v_mfma_f32_16x16x32_bf16 v[56:59], a[244:247], v[72:75], v[56:59]
  buffer_store_dwordx4 v[28:31], v24, s[8:11], s72 offen offset:1024 sc1
  v_mfma_f32_16x16x32_bf16 v[36:39], a[52:55], v[76:79], v[36:39]
  s_add_u32 s72, s72, s73
  v_mfma_f32_16x16x32_bf16 v[44:47], a[116:119], v[76:79], v[44:47]
  v_mfma_f32_16x16x32_bf16 v[52:55], a[180:183], v[76:79], v[52:55]
  v_mfma_f32_16x16x32_bf16 v[60:63], a[244:247], v[76:79], v[60:63]
  s_waitcnt lgkmcnt(2)
  v_mfma_f32_16x16x32_bf16 v[32:35], a[56:59], v[80:83], v[32:35]
  v_mfma_f32_16x16x32_bf16 v[40:43], a[120:123], v[80:83], v[40:43]
  v_mfma_f32_16x16x32_bf16 v[48:51], a[184:187], v[80:83], v[48:51]
  s_add_u32 s55, s55, 32768
  v_mfma_f32_16x16x32_bf16 v[56:59], a[248:251], v[80:83], v[56:59]
  s_cmp_eq_u32 s55, 98304
  s_cselect_b32 s55, 0, s55
  v_mfma_f32_16x16x32_bf16 v[36:39], a[56:59], v[84:87], v[36:39]
  s_add_u32 s48, s47, s59
  v_mfma_f32_16x16x32_bf16 v[44:47], a[120:123], v[84:87], v[44:47]
  v_mfma_f32_16x16x32_bf16 v[52:55], a[184:187], v[84:87], v[52:55]
  v_mfma_f32_16x16x32_bf16 v[60:63], a[248:251], v[84:87], v[60:63]
  s_waitcnt lgkmcnt(0)
  v_mfma_f32_16x16x32_bf16 v[32:35], a[60:63], v[88:91], v[32:35]
  v_mfma_f32_16x16x32_bf16 v[40:43], a[124:127], v[88:91], v[40:43]
  v_mfma_f32_16x16x32_bf16 v[48:51], a[188:191], v[88:91], v[48:51]
  v_mfma_f32_16x16x32_bf16 v[56:59], a[252:255], v[88:91], v[56:59]
  v_mfma_f32_16x16x32_bf16 v[36:39], a[60:63], v[92:95], v[36:39]
  v_mfma_f32_16x16x32_bf16 v[44:47], a[124:127], v[92:95], v[44:47]
  v_mfma_f32_16x16x32_bf16 v[52:55], a[188:191], v[92:95], v[52:55]
  v_mfma_f32_16x16x32_bf16 v[60:63], a[252:255], v[92:95], v[60:63]
  v_add_u32 v20, s55, v16
  v_add_u32 v21, s55, v17
  v_add_u32 v22, s55, v18
  v_add_u32 v23, s55, v19
  s_barrier
  ds_read_b128 v[64:67], v20 offset:0
  ds_read_b128 v[68:71], v20 offset:16384
  ds_read_b128 v[72:75], v21 offset:0
  ds_read_b128 v[76:79], v21 offset:16384
  ds_read_b128 v[80:83], v22 offset:0
  ds_read_b128 v[84:87], v22 offset:16384
  v_cvt_pk_bf16_f32 v96, v32, v33
  v_cvt_pk_bf16_f32 v97, v34, v35
  v_cvt_pk_bf16_f32 v98, v40, v41
  v_cvt_pk_bf16_f32 v99, v42, v43
  buffer_store_dwordx4 v[96:99], v24, s[8:11], s47 offen offset:0 sc1
  v_cvt_pk_bf16_f32 v100, v48, v49
  v_cvt_pk_bf16_f32 v101, v50, v51
  v_cvt_pk_bf16_f32 v102, v56, v57
  v_cvt_pk_bf16_f32 v103, v58, v59
  buffer_store_dwordx4 v[100:103], v24, s[8:11], s47 offen offset:1024 sc1
  v_cvt_pk_bf16_f32 v104, v36, v37
  v_cvt_pk_bf16_f32 v105, v38, v39
  v_cvt_pk_bf16_f32 v106, v44, v45
  v_cvt_pk_bf16_f32 v107, v46, v47
  buffer_store_dwordx4 v[104:107], v24, s[8:11], s48 offen offset:0 sc1
  v_cvt_pk_bf16_f32 v108, v52, v53
  v_cvt_pk_bf16_f32 v109, v54, v55
  v_cvt_pk_bf16_f32 v110, v60, v61
  v_cvt_pk_bf16_f32 v111, v62, v63
  buffer_store_dwordx4 v[108:111], v24, s[8:11], s48 offen offset:1024 sc1
  s_add_u32 s47, s47, s49
  s_add_u32 s53, s53, 1
  s_cmp_lt_u32 s53, s54
  s_cbranch_scc1 L_A_loopK
  s_branch L_A_fin
L_A_loopV:
  s_waitcnt lgkmcnt(4)
  v_mfma_f32_16x16x32_bf16 v[32:35], v[64:67], a[0:3], 0
  ds_read_b128 v[88:91], v23 offset:0
  v_mfma_f32_16x16x32_bf16 v[40:43], v[64:67], a[64:67], 0
  ds_read_b128 v[92:95], v23 offset:16384
  v_mfma_f32_16x16x32_bf16 v[48:51], v[64:67], a[128:131], 0
  s_add_u32 s58, s57, s56
  v_mfma_f32_16x16x32_bf16 v[56:59], v[64:67], a[192:195], 0
  s_add_u32 m0, s58, 0
  v_mfma_f32_16x16x32_bf16 v[36:39], v[68:71], a[0:3], 0
  buffer_load_dwordx4 v8, s[4:7], s51 offen offset:0 lds
  v_mfma_f32_16x16x32_bf16 v[44:47], v[68:71], a[64:67], 0
  buffer_load_dwordx4 v9, s[4:7], s51 offen offset:1024 lds
  v_mfma_f32_16x16x32_bf16 v[52:55], v[68:71], a[128:131], 0
  buffer_load_dwordx4 v10, s[4:7], s51 offen offset:2048 lds
  v_mfma_f32_16x16x32_bf16 v[60:63], v[68:71], a[192:195], 0
  s_waitcnt lgkmcnt(4)
  v_mfma_f32_16x16x32_bf16 v[32:35], v[72:75], a[4:7], v[32:35]
  ds_read_b128 v[64:67], v20 offset:256
  v_mfma_f32_16x16x32_bf16 v[40:43], v[72:75], a[68:71], v[40:43]
  ds_read_b128 v[68:71], v20 offset:16640
  v_mfma_f32_16x16x32_bf16 v[48:51], v[72:75], a[132:135], v[48:51]
  buffer_load_dwordx4 v11, s[4:7], s51 offen offset:3072 lds
  v_mfma_f32_16x16x32_bf16 v[56:59], v[72:75], a[196:199], v[56:59]
  s_add_u32 s58, s57, s56
  v_mfma_f32_16x16x32_bf16 v[36:39], v[76:79], a[4:7], v[36:39]
  s_add_u32 m0, s58, 4096
  v_mfma_f32_16x16x32_bf16 v[44:47], v[76:79], a[68:71], v[44:47]
  buffer_load_dwordx4 v12, s[4:7], s51 offen offset:0 lds
  v_mfma_f32_16x16x32_bf16 v[52:55], v[76:79], a[132:135], v[52:55]
  buffer_load_dwordx4 v13, s[4:7], s51 offen offset:1024 lds
  v_mfma_f32_16x16x32_bf16 v[60:63], v[76:79], a[196:199], v[60:63]
  s_waitcnt lgkmcnt(4)
  v_mfma_f32_16x16x32_bf16 v[32:35], v[80:83], a[8:11], v[32:35]
  ds_read_b128 v[72:75], v21 offset:256
  v_mfma_f32_16x16x32_bf16 v[40:43], v[80:83], a[72:75], v[40:43]
  ds_read_b128 v[76:79], v21 offset:16640
  v_mfma_f32_16x16x32_bf16 v[48:51], v[80:83], a[136:139], v[48:51]
  buffer_load_dwordx4 v14, s[4:7], s51 offen offset:2048 lds
  v_mfma_f32_16x16x32_bf16 v[56:59], v[80:83], a[200:203], v[56:59]
  buffer_load_dwordx4 v15, s[4:7], s51 offen offset:3072 lds
  v_mfma_f32_16x16x32_bf16 v[36:39], v[84:87], a[8:11], v[36:39]
  s_add_u32 s51, s51, s52
  v_mfma_f32_16x16x32_bf16 v[44:47], v[84:87], a[72:75], v[44:47]
  s_add_u32 s56, s56, 32768
  v_mfma_f32_16x16x32_bf16 v[52:55], v[84:87], a[136:139], v[52:55]
  s_cmp_eq_u32 s56, 98304
  v_mfma_f32_16x16x32_bf16 v[60:63], v[84:87], a[200:203], v[60:63]
  s_waitcnt lgkmcnt(4)
  v_mfma_f32_16x16x32_bf16 v[32:35], v[88:91], a[12:15], v[32:35]
  ds_read_b128 v[80:83], v22 offset:256
  v_mfma_f32_16x16x32_bf16 v[40:43], v[88:91], a[76:79], v[40:43]
  ds_read_b128 v[84:87], v22 offset:16640
  v_mfma_f32_16x16x32_bf16 v[48:51], v[88:91], a[140:143], v[48:51]
  s_cselect_b32 s56, 0, s56
  v_mfma_f32_16x16x32_bf16 v[56:59], v[88:91], a[204:207], v[56:59]
  v_mfma_f32_16x16x32_bf16 v[36:39], v[92:95], a[12:15], v[36:39]
  v_mfma_f32_16x16x32_bf16 v[44:47], v[92:95], a[76:79], v[44:47]
  v_mfma_f32_16x16x32_bf16 v[52:55], v[92:95], a[140:143], v[52:55]
  v_mfma_f32_16x16x32_bf16 v[60:63], v[92:95], a[204:207], v[60:63]
  s_waitcnt lgkmcnt(4)
  v_mfma_f32_16x16x32_bf16 v[32:35], v[64:67], a[16:19], v[32:35]
  ds_read_b128 v[88:91], v23 offset:256
  v_mfma_f32_16x16x32_bf16 v[40:43], v[64:67], a[80:83], v[40:43]
  ds_read_b128 v[92:95], v23 offset:16640
  v_mfma_f32_16x16x32_bf16 v[48:51], v[64:67], a[144:147], v[48:51]
  v_mfma_f32_16x16x32_bf16 v[56:59], v[64:67], a[208:211], v[56:59]
  v_mfma_f32_16x16x32_bf16 v[36:39], v[68:71], a[16:19], v[36:39]
  v_mfma_f32_16x16x32_bf16 v[44:47], v[68:71], a[80:83], v[44:47]
  v_mfma_f32_16x16x32_bf16 v[52:55], v[68:71], a[144:147], v[52:55]
  v_mfma_f32_16x16x32_bf16 v[60:63], v[68:71], a[208:211], v[60:63]
  s_waitcnt lgkmcnt(4)
  v_mfma_f32_16x16x32_bf16 v[32:35], v[72:75], a[20:23], v[32:35]
  ds_read_b128 v[64:67], v20 offset:512
  v_mfma_f32_16x16x32_bf16 v[40:43], v[72:75], a[84:87], v[40:43]
  ds_read_b128 v[68:71], v20 offset:16896
  v_mfma_f32_16x16x32_bf16 v[48:51], v[72:75], a[148:151], v[48:51]
  v_mfma_f32_16x16x32_bf16 v[56:59], v[72:75], a[212:215], v[56:59]
  v_mfma_f32_16x16x32_bf16 v[36:39], v[76:79], a[20:23], v[36:39]
  v_mfma_f32_16x16x32_bf16 v[44:47], v[76:79], a[84:87], v[44:47]
  v_mfma_f32_16x16x32_bf16 v[52:55], v[76:79], a[148:151], v[52:55]
  v_mfma_f32_16x16x32_bf16 v[60:63], v[76:79], a[212:215], v[60:63]
  s_waitcnt lgkmcnt(4)
  v_mfma_f32_16x16x32_bf16 v[32:35], v[80:83], a[24:27], v[32:35]
  ds_read_b128 v[72:75], v21 offset:512
  v_mfma_f32_16x16x32_bf16 v[40:43], v[80:83], a[88:91], v[40:43]
  ds_read_b128 v[76:79], v21 offset:16896
  v_mfma_f32_16x16x32_bf16 v[48:51], v[80:83], a[152:155], v[48:51]
  v_mfma_f32_16x16x32_bf16 v[56:59], v[80:83], a[216:219], v[56:59]
  v_mfma_f32_16x16x32_bf16 v[36:39], v[84:87], a[24:27], v[36:39]
  v_mfma_f32_16x16x32_bf16 v[44:47], v[84:87], a[88:91], v[44:47]
  v_mfma_f32_16x16x32_bf16 v[52:55], v[84:87], a[152:155], v[52:55]
  v_mfma_f32_16x16x32_bf16 v[60:63], v[84:87], a[216:219], v[60:63]
  s_waitcnt lgkmcnt(4)
  v_mfma_f32_16x16x32_bf16 v[32:35], v[88:91], a[28:31], v[32:35]
  ds_read_b128 v[80:83], v22 offset:512
  v_mfma_f32_16x16x32_bf16 v[40:43], v[88:91], a[92:95], v[40:43]
  ds_read_b128 v[84:87], v22 offset:16896
  v_mfma_f32_16x16x32_bf16 v[48:51], v[88:91], a[156:159], v[48:51]
  v_mfma_f32_16x16x32_bf16 v[56:59], v[88:91], a[220:223], v[56:59]
  v_mfma_f32_16x16x32_bf16 v[36:39], v[92:95], a[28:31], v[36:39]
  v_mfma_f32_16x16x32_bf16 v[44:47], v[92:95], a[92:95], v[44:47]
  v_mfma_f32_16x16x32_bf16 v[52:55], v[92:95], a[156:159], v[52:55]
  v_mfma_f32_16x16x32_bf16 v[60:63], v[92:95], a[220:223], v[60:63]
  s_waitcnt lgkmcnt(4)
  v_mfma_f32_16x16x32_bf16 v[32:35], v[64:67], a[32:35], v[32:35]
  ds_read_b128 v[88:91], v23 offset:512
  v_mfma_f32_16x16x32_bf16 v[40:43], v[64:67], a[96:99], v[40:43]
  ds_read_b128 v[92:95], v23 offset:16896
  v_mfma_f32_16x16x32_bf16 v[48:51], v[64:67], a[160:163], v[48:51]
  v_mfma_f32_16x16x32_bf16 v[56:59], v[64:67], a[224:227], v[56:59]
  v_mfma_f32_16x16x32_bf16 v[36:39], v[68:71], a[32:35], v[36:39]
  v_mfma_f32_16x16x32_bf16 v[44:47], v[68:71], a[96:99], v[44:47]
  v_mfma_f32_16x16x32_bf16 v[52:55], v[68:71], a[160:163], v[52:55]
  v_mfma_f32_16x16x32_bf16 v[60:63], v[68:71], a[224:227], v[60:63]
  s_waitcnt lgkmcnt(4)
  v_mfma_f32_16x16x32_bf16 v[32:35], v[72:75], a[36:39], v[32:35]
  ds_read_b128 v[64:67], v20 offset:768
  v_mfma_f32_16x16x32_bf16 v[40:43], v[72:75], a[100:103], v[40:43]
  ds_read_b128 v[68:71], v20 offset:17152
  v_mfma_f32_16x16x32_bf16 v[48:51], v[72:75], a[164:167], v[48:51]
  v_mfma_f32_16x16x32_bf16 v[56:59], v[72:75], a[228:231], v[56:59]
  v_mfma_f32_16x16x32_bf16 v[36:39], v[76:79], a[36:39], v[36:39]
  v_mfma_f32_16x16x32_bf16 v[44:47], v[76:79], a[100:103], v[44:47]
  v_mfma_f32_16x16x32_bf16 v[52:55], v[76:79], a[164:167], v[52:55]
  v_mfma_f32_16x16x32_bf16 v[60:63], v[76:79], a[228:231], v[60:63]
  s_waitcnt lgkmcnt(4)
  v_mfma_f32_16x16x32_bf16 v[32:35], v[80:83], a[40:43], v[32:35]
  ds_read_b128 v[72:75], v21 offset:768
  v_mfma_f32_16x16x32_bf16 v[40:43], v[80:83], a[104:107], v[40:43]
  ds_read_b128 v[76:79], v21 offset:17152
  v_mfma_f32_16x16x32_bf16 v[48:51], v[80:83], a[168:171], v[48:51]
  s_add_u32 s36, s53, s30
  v_mfma_f32_16x16x32_bf16 v[56:59], v[80:83], a[232:235], v[56:59]
  v_mov_b32 v26, s36
  v_mfma_f32_16x16x32_bf16 v[36:39], v[84:87], a[40:43], v[36:39]
  s_waitcnt vmcnt(8)
  s_bitcmp1_b32 0x4116, s53
  v_mfma_f32_16x16x32_bf16 v[44:47], v[84:87], a[104:107], v[44:47]
  s_cbranch_scc0 L_A_nfV
  s_mov_b64 exec, 1
  buffer_store_dwordx2 v[26:27], v25, s[8:11], s50 offen sc1
  s_mov_b64 exec, -1
L_A_nfV:
  v_mfma_f32_16x16x32_bf16 v[52:55], v[84:87], a[168:171], v[52:55]
  v_mfma_f32_16x16x32_bf16 v[60:63], v[84:87], a[232:235], v[60:63]
  s_waitcnt lgkmcnt(4)
  v_mfma_f32_16x16x32_bf16 v[32:35], v[88:91], a[44:47], v[32:35]
  ds_read_b128 v[80:83], v22 offset:768
  v_mfma_f32_16x16x32_bf16 v[40:43], v[88:91], a[108:111], v[40:43]
  ds_read_b128 v[84:87], v22 offset:17152
  v_mfma_f32_16x16x32_bf16 v[48:51], v[88:91], a[172:175], v[48:51]
  v_mfma_f32_16x16x32_bf16 v[56:59], v[88:91], a[236:239], v[56:59]
  v_mfma_f32_16x16x32_bf16 v[36:39], v[92:95], a[44:47], v[36:39]
  v_mfma_f32_16x16x32_bf16 v[44:47], v[92:95], a[108:111], v[44:47]
  v_mfma_f32_16x16x32_bf16 v[52:55], v[92:95], a[172:175], v[52:55]
  v_mfma_f32_16x16x32_bf16 v[60:63], v[92:95], a[236:239], v[60:63]
  s_waitcnt lgkmcnt(4)
  v_mfma_f32_16x16x32_bf16 v[32:35], v[64:67], a[48:51], v[32:35]
  ds_read_b128 v[88:91], v23 offset:768
  v_mfma_f32_16x16x32_bf16 v[40:43], v[64:67], a[112:115], v[40:43]
  ds_read_b128 v[92:95], v23 offset:17152
  v_mfma_f32_16x16x32_bf16 v[48:51], v[64:67], a[176:179], v[48:51]
  v_mfma_f32_16x16x32_bf16 v[56:59], v[64:67], a[240:243], v[56:59]
  v_mfma_f32_16x16x32_bf16 v[36:39], v[68:71], a[48:51], v[36:39]
  v_mfma_f32_16x16x32_bf16 v[44:47], v[68:71], a[112:115], v[44:47]
  v_mfma_f32_16x16x32_bf16 v[52:55], v[68:71], a[176:179], v[52:55]
  v_mfma_f32_16x16x32_bf16 v[60:63], v[68:71], a[240:243], v[60:63]
  s_waitcnt lgkmcnt(4)
  v_mfma_f32_16x16x32_bf16 v[32:35], v[72:75], a[52:55], v[32:35]
  v_mfma_f32_16x16x32_bf16 v[40:43], v[72:75], a[116:119], v[40:43]
  v_mfma_f32_16x16x32_bf16 v[48:51], v[72:75], a[180:183], v[48:51]
  buffer_store_dwordx4 v[28:31], v24, s[8:11], s72 offen sc1
  v_mfma_f32_16x16x32_bf16 v[56:59], v[72:75], a[244:247], v[56:59]
  buffer_store_dwordx4 v[28:31], v24, s[8:11], s72 offen offset:1024 sc1
  v_mfma_f32_16x16x32_bf16 v[36:39], v[76:79], a[52:55], v[36:39]
  s_add_u32 s72, s72, s73
  v_mfma_f32_16x16x32_bf16 v[44:47], v[76:79], a[116:119], v[44:47]
  v_mfma_f32_16x16x32_bf16 v[52:55], v[76:79], a[180:183], v[52:55]
  v_mfma_f32_16x16x32_bf16 v[60:63], v[76:79], a[244:247], v[60:63]
  s_waitcnt lgkmcnt(2)
  v_mfma_f32_16x16x32_bf16 v[32:35], v[80:83], a[56:59], v[32:35]
  v_mfma_f32_16x16x32_bf16 v[40:43], v[80:83], a[120:123], v[40:43]
  v_mfma_f32_16x16x32_bf16 v[48:51], v[80:83], a[184:187], v[48:51]
  s_add_u32 s55, s55, 32768
  v_mfma_f32_16x16x32_bf16 v[56:59], v[80:83], a[248:251], v[56:59]
  s_cmp_eq_u32 s55, 98304
  s_cselect_b32 s55, 0, s55
  v_mfma_f32_16x16x32_bf16 v[36:39], v[84:87], a[56:59], v[36:39]
  s_add_u32 s48, s47, s59
  v_mfma_f32_16x16x32_bf16 v[44:47], v[84:87], a[120:123], v[44:47]
  v_mfma_f32_16x16x32_bf16 v[52:55], v[84:87], a[184:187], v[52:55]
  v_mfma_f32_16x16x32_bf16 v[60:63], v[84:87], a[248:251], v[60:63]
  s_waitcnt lgkmcnt(0)
  v_mfma_f32_16x16x32_bf16 v[32:35], v[88:91], a[60:63], v[32:35]
  v_mfma_f32_16x16x32_bf16 v[40:43], v[88:91], a[124:127], v[40:43]
  v_mfma_f32_16x16x32_bf16 v[48:51], v[88:91], a[188:191], v[48:51]
  v_mfma_f32_16x16x32_bf16 v[56:59], v[88:91], a[252:255], v[56:59]
  v_mfma_f32_16x16x32_bf16 v[36:39], v[92:95], a[60:63], v[36:39]
  v_mfma_f32_16x16x32_bf16 v[44:47], v[92:95], a[124:127], v[44:47]
  v_mfma_f32_16x16x32_bf16 v[52:55], v[92:95], a[188:191], v[52:55]
  v_mfma_f32_16x16x32_bf16 v[60:63], v[92:95], a[252:255], v[60:63]
  v_add_u32 v20, s55, v16
  v_add_u32 v21, s55, v17
  v_add_u32 v22, s55, v18
  v_add_u32 v23, s55, v19
  s_barrier
  ds_read_b128 v[64:67], v20 offset:0
  ds_read_b128 v[68:71], v20 offset:16384
  ds_read_b128 v[72:75], v21 offset:0
  ds_read_b128 v[76:79], v21 offset:16384
  ds_read_b128 v[80:83], v22 offset:0
  ds_read_b128 v[84:87], v22 offset:16384
  v_cvt_pk_bf16_f32 v96, v32, v33
  v_cvt_pk_bf16_f32 v97, v34, v35
  v_cvt_pk_bf16_f32 v98, v36, v37
  v_cvt_pk_bf16_f32 v99, v38, v39
  buffer_store_dwordx4 v[96:99], v24, s[8:11], s47 offen offset:0 sc1
  v_cvt_pk_bf16_f32 v100, v40, v41
  v_cvt_pk_bf16_f32 v101, v42, v43
  v_cvt_pk_bf16_f32 v102, v44, v45
  v_cvt_pk_bf16_f32 v103, v46, v47
  buffer_store_dwordx4 v[100:103], v24, s[8:11], s47 offen offset:1024 sc1
  v_cvt_pk_bf16_f32 v104, v48, v49
  v_cvt_pk_bf16_f32 v105, v50, v51
  v_cvt_pk_bf16_f32 v106, v52, v53
  v_cvt_pk_bf16_f32 v107, v54, v55
  buffer_store_dwordx4 v[104:107], v24, s[8:11], s47 offen offset:2048 sc1
  v_cvt_pk_bf16_f32 v108, v56, v57
  v_cvt_pk_bf16_f32 v109, v58, v59
  v_cvt_pk_bf16_f32 v110, v60, v61
  v_cvt_pk_bf16_f32 v111, v62, v63
  buffer_store_dwordx4 v[108:111], v24, s[8:11], s47 offen offset:3072 sc1
  s_add_u32 s47, s47, s49
  s_add_u32 s53, s53, 1
  s_cmp_lt_u32 s53, s54
  s_cbranch_scc1 L_A_loopV
  s_branch L_A_fin
L_A_loopF:
  s_waitcnt lgkmcnt(4)
  v_mfma_f32_16x16x32_bf16 v[32:35], a[0:3], v[64:67], 0
  ds_read_b128 v[88:91], v23 offset:0
  v_mfma_f32_16x16x32_bf16 v[40:43], a[64:67], v[64:67], 0
  ds_read_b128 v[92:95], v23 offset:16384
  v_mfma_f32_16x16x32_bf16 v[48:51], a[128:131], v[64:67], 0
  s_add_u32 s58, s57, s56
  v_mfma_f32_16x16x32_bf16 v[56:59], a[192:195], v[64:67], 0
  s_add_u32 m0, s58, 0
  v_mfma_f32_16x16x32_bf16 v[36:39], a[0:3], v[68:71], 0
  buffer_load_dwordx4 v8, s[4:7], s51 offen offset:0 lds
  v_mfma_f32_16x16x32_bf16 v[44:47], a[64:67], v[68:71], 0
  buffer_load_dwordx4 v9, s[4:7], s51 offen offset:1024 lds
  v_mfma_f32_16x16x32_bf16 v[52:55], a[128:131], v[68:71], 0
  buffer_load_dwordx4 v10, s[4:7], s51 offen offset:2048 lds
  v_mfma_f32_16x16x32_bf16 v[60:63], a[192:195], v[68:71], 0
  s_waitcnt lgkmcnt(4)
  v_mfma_f32_16x16x32_bf16 v[32:35], a[4:7], v[72:75], v[32:35]
  ds_read_b128 v[64:67], v20 offset:256
  v_mfma_f32_16x16x32_bf16 v[40:43], a[68:71], v[72:75], v[40:43]
  ds_read_b128 v[68:71], v20 offset:16640
  v_mfma_f32_16x16x32_bf16 v[48:51], a[132:135], v[72:75], v[48:51]
  buffer_load_dwordx4 v11, s[4:7], s51 offen offset:3072 lds
  v_mfma_f32_16x16x32_bf16 v[56:59], a[196:199], v[72:75], v[56:59]
  s_add_u32 s58, s57, s56
  v_mfma_f32_16x16x32_bf16 v[36:39], a[4:7], v[76:79], v[36:39]
  s_add_u32 m0, s58, 4096
  v_mfma_f32_16x16x32_bf16 v[44:47], a[68:71], v[76:79], v[44:47]
  buffer_load_dwordx4 v12, s[4:7], s51 offen offset:0 lds
  v_mfma_f32_16x16x32_bf16 v[52:55], a[132:135], v[76:79], v[52:55]
  buffer_load_dwordx4 v13, s[4:7], s51 offen offset:1024 lds
  v_mfma_f32_16x16x32_bf16 v[60:63], a[196:199], v[76:79], v[60:63]
  s_waitcnt lgkmcnt(4)
  v_mfma_f32_16x16x32_bf16 v[32:35], a[8:11], v[80:83], v[32:35]
  ds_read_b128 v[72:75], v21 offset:256
  v_mfma_f32_16x16x32_bf16 v[40:43], a[72:75], v[80:83], v[40:43]
  ds_read_b128 v[76:79], v21 offset:16640
  v_mfma_f32_16x16x32_bf16 v[48:51], a[136:139], v[80:83], v[48:51]
  buffer_load_dwordx4 v14, s[4:7], s51 offen offset:2048 lds
  v_mfma_f32_16x16x32_bf16 v[56:59], a[200:203], v[80:83], v[56:59]
  buffer_load_dwordx4 v15, s[4:7], s51 offen offset:3072 lds
  v_mfma_f32_16x16x32_bf16 v[36:39], a[8:11], v[84:87], v[36:39]
  s_add_u32 s51, s51, s52
  v_mfma_f32_16x16x32_bf16 v[44:47], a[72:75], v[84:87], v[44:47]
  s_add_u32 s56, s56, 32768
  v_mfma_f32_16x16x32_bf16 v[52:55], a[136:139], v[84:87], v[52:55]
  s_cmp_eq_u32 s56, 98304
  v_mfma_f32_16x16x32_bf16 v[60:63], a[200:203], v[84:87], v[60:63]
  s_waitcnt lgkmcnt(4)
  v_mfma_f32_16x16x32_bf16 v[32:35], a[12:15], v[88:91], v[32:35]
  ds_read_b128 v[80:83], v22 offset:256
  v_mfma_f32_16x16x32_bf16 v[40:43], a[76:79], v[88:91], v[40:43]
  ds_read_b128 v[84:87], v22 offset:16640
  v_mfma_f32_16x16x32_bf16 v[48:51], a[140:143], v[88:91], v[48:51]
  s_cselect_b32 s56, 0, s56
  v_mfma_f32_16x16x32_bf16 v[56:59], a[204:207], v[88:91], v[56:59]
  v_mfma_f32_16x16x32_bf16 v[36:39], a[12:15], v[92:95], v[36:39]
  v_mfma_f32_16x16x32_bf16 v[44:47], a[76:79], v[92:95], v[44:47]
  v_mfma_f32_16x16x32_bf16 v[52:55], a[140:143], v[92:95], v[52:55]
  v_mfma_f32_16x16x32_bf16 v[60:63], a[204:207], v[92:95], v[60:63]
  s_waitcnt lgkmcnt(4)
  v_mfma_f32_16x16x32_bf16 v[32:35], a[16:19], v[64:67], v[32:35]
  ds_read_b128 v[88:91], v23 offset:256
  v_mfma_f32_16x16x32_bf16 v[40:43], a[80:83], v[64:67], v[40:43]
  ds_read_b128 v[92:95], v23 offset:16640
  v_mfma_f32_16x16x32_bf16 v[48:51], a[144:147], v[64:67], v[48:51]
  v_mfma_f32_16x16x32_bf16 v[56:59], a[208:211], v[64:67], v[56:59]
  v_mfma_f32_16x16x32_bf16 v[36:39], a[16:19], v[68:71], v[36:39]
  v_mfma_f32_16x16x32_bf16 v[44:47], a[80:83], v[68:71], v[44:47]
  v_mfma_f32_16x16x32_bf16 v[52:55], a[144:147], v[68:71], v[52:55]
  v_mfma_f32_16x16x32_bf16 v[60:63], a[208:211], v[68:71], v[60:63]
  s_waitcnt lgkmcnt(4)
  v_mfma_f32_16x16x32_bf16 v[32:35], a[20:23], v[72:75], v[32:35]
  ds_read_b128 v[64:67], v20 offset:512
  v_mfma_f32_16x16x32_bf16 v[40:43], a[84:87], v[72:75], v[40:43]
  ds_read_b128 v[68:71], v20 offset:16896
  v_mfma_f32_16x16x32_bf16 v[48:51], a[148:151], v[72:75], v[48:51]
  v_mfma_f32_16x16x32_bf16 v[56:59], a[212:215], v[72:75], v[56:59]
  v_mfma_f32_16x16x32_bf16 v[36:39], a[20:23], v[76:79], v[36:39]
  v_mfma_f32_16x16x32_bf16 v[44:47], a[84:87], v[76:79], v[44:47]
  v_mfma_f32_16x16x32_bf16 v[52:55], a[148:151], v[76:79], v[52:55]
  v_mfma_f32_16x16x32_bf16 v[60:63], a[212:215], v[76:79], v[60:63]
  s_waitcnt lgkmcnt(4)
  v_mfma_f32_16x16x32_bf16 v[32:35], a[24:27], v[80:83], v[32:35]
  ds_read_b128 v[72:75], v21 offset:512
  v_mfma_f32_16x16x32_bf16 v[40:43], a[88:91], v[80:83], v[40:43]
  ds_read_b128 v[76:79], v21 offset:16896
  v_mfma_f32_16x16x32_bf16 v[48:51], a[152:155], v[80:83], v[48:51]
  v_mfma_f32_16x16x32_bf16 v[56:59], a[216:219], v[80:83], v[56:59]
  v_mfma_f32_16x16x32_bf16 v[36:39], a[24:27], v[84:87], v[36:39]
  v_mfma_f32_16x16x32_bf16 v[44:47], a[88:91], v[84:87], v[44:47]
  v_mfma_f32_16x16x32_bf16 v[52:55], a[152:155], v[84:87], v[52:55]
  v_mfma_f32_16x16x32_bf16 v[60:63], a[216:219], v[84:87], v[60:63]
  s_waitcnt lgkmcnt(4)
  v_mfma_f32_16x16x32_bf16 v[32:35], a[28:31], v[88:91], v[32:35]
  ds_read_b128 v[80:83], v22 offset:512
  v_mfma_f32_16x16x32_bf16 v[40:43], a[92:95], v[88:91], v[40:43]
  ds_read_b128 v[84:87], v22 offset:16896
  v_mfma_f32_16x16x32_bf16 v[48:51], a[156:159], v[88:91], v[48:51]
  v_mfma_f32_16x16x32_bf16 v[56:59], a[220:223], v[88:91], v[56:59]
  v_mfma_f32_16x16x32_bf16 v[36:39], a[28:31], v[92:95], v[36:39]
  v_mfma_f32_16x16x32_bf16 v[44:47], a[92:95], v[92:95], v[44:47]
  v_mfma_f32_16x16x32_bf16 v[52:55], a[156:159], v[92:95], v[52:55]
  v_mfma_f32_16x16x32_bf16 v[60:63], a[220:223], v[92:95], v[60:63]
  s_waitcnt lgkmcnt(4)
  v_mfma_f32_16x16x32_bf16 v[32:35], a[32:35], v[64:67], v[32:35]
  ds_read_b128 v[88:91], v23 offset:512
  v_mfma_f32_16x16x32_bf16 v[40:43], a[96:99], v[64:67], v[40:43]
  ds_read_b128 v[92:95], v23 offset:16896
  v_mfma_f32_16x16x32_bf16 v[48:51], a[160:163], v[64:67], v[48:51]
  v_mfma_f32_16x16x32_bf16 v[56:59], a[224:227], v[64:67], v[56:59]
  v_mfma_f32_16x16x32_bf16 v[36:39], a[32:35], v[68:71], v[36:39]
  v_mfma_f32_16x16x32_bf16 v[44:47], a[96:99], v[68:71], v[44:47]
  v_mfma_f32_16x16x32_bf16 v[52:55], a[160:163], v[68:71], v[52:55]
  v_mfma_f32_16x16x32_bf16 v[60:63], a[224:227], v[68:71], v[60:63]
  s_waitcnt lgkmcnt(4)
  v_mfma_f32_16x16x32_bf16 v[32:35], a[36:39], v[72:75], v[32:35]
  ds_read_b128 v[64:67], v20 offset:768
  v_mfma_f32_16x16x32_bf16 v[40:43], a[100:103], v[72:75], v[40:43]
  ds_read_b128 v[68:71], v20 offset:17152
  v_mfma_f32_16x16x32_bf16 v[48:51], a[164:167], v[72:75], v[48:51]
  v_mfma_f32_16x16x32_bf16 v[56:59], a[228:231], v[72:75], v[56:59]
  v_mfma_f32_16x16x32_bf16 v[36:39], a[36:39], v[76:79], v[36:39]
  v_mfma_f32_16x16x32_bf16 v[44:47], a[100:103], v[76:79], v[44:47]
  v_mfma_f32_16x16x32_bf16 v[52:55], a[164:167], v[76:79], v[52:55]
  v_mfma_f32_16x16x32_bf16 v[60:63], a[228:231], v[76:79], v[60:63]
  s_waitcnt lgkmcnt(4)
  v_mfma_f32_16x16x32_bf16 v[32:35], a[40:43], v[80:83], v[32:35]
  ds_read_b128 v[72:75], v21 offset:768
  v_mfma_f32_16x16x32_bf16 v[40:43], a[104:107], v[80:83], v[40:43]
  ds_read_b128 v[76:79], v21 offset:17152
  v_mfma_f32_16x16x32_bf16 v[48:51], a[168:171], v[80:83], v[48:51]
  s_waitcnt vmcnt(8)
  v_mfma_f32_16x16x32_bf16 v[56:59], a[232:235], v[80:83], v[56:59]
  v_mfma_f32_16x16x32_bf16 v[36:39], a[40:43], v[84:87], v[36:39]
  v_mfma_f32_16x16x32_bf16 v[44:47], a[104:107], v[84:87], v[44:47]
  v_mfma_f32_16x16x32_bf16 v[52:55], a[168:171], v[84:87], v[52:55]
  v_mfma_f32_16x16x32_bf16 v[60:63], a[232:235], v[84:87], v[60:63]
  s_waitcnt lgkmcnt(4)
  v_mfma_f32_16x16x32_bf16 v[32:35], a[44:47], v[88:91], v[32:35]
  ds_read_b128 v[80:83], v22 offset:768
  v_mfma_f32_16x16x32_bf16 v[40:43], a[108:111], v[88:91], v[40:43]
  ds_read_b128 v[84:87], v22 offset:17152
  v_mfma_f32_16x16x32_bf16 v[48:51], a[172:175], v[88:91], v[48:51]
  v_mfma_f32_16x16x32_bf16 v[56:59], a[236:239], v[88:91], v[56:59]
  v_mfma_f32_16x16x32_bf16 v[36:39], a[44:47], v[92:95], v[36:39]
  v_mfma_f32_16x16x32_bf16 v[44:47], a[108:111], v[92:95], v[44:47]
  v_mfma_f32_16x16x32_bf16 v[52:55], a[172:175], v[92:95], v[52:55]
  v_mfma_f32_16x16x32_bf16 v[60:63], a[236:239], v[92:95], v[60:63]
  s_waitcnt lgkmcnt(4)
  v_mfma_f32_16x16x32_bf16 v[32:35], a[48:51], v[64:67], v[32:35]
  ds_read_b128 v[88:91], v23 offset:768
  v_mfma_f32_16x16x32_bf16 v[40:43], a[112:115], v[64:67], v[40:43]
  ds_read_b128 v[92:95], v23 offset:17152
  v_mfma_f32_16x16x32_bf16 v[48:51], a[176:179], v[64:67], v[48:51]
  v_mfma_f32_16x16x32_bf16 v[56:59], a[240:243], v[64:67], v[56:59]
  v_mfma_f32_16x16x32_bf16 v[36:39], a[48:51], v[68:71], v[36:39]
  v_mfma_f32_16x16x32_bf16 v[44:47], a[112:115], v[68:71], v[44:47]
  v_mfma_f32_16x16x32_bf16 v[52:55], a[176:179], v[68:71], v[52:55]
  v_mfma_f32_16x16x32_bf16 v[60:63], a[240:243], v[68:71], v[60:63]
  s_waitcnt lgkmcnt(4)
  v_mfma_f32_16x16x32_bf16 v[32:35], a[52:55], v[72:75], v[32:35]
  v_mfma_f32_16x16x32_bf16 v[40:43], a[116:119], v[72:75], v[40:43]
  v_mfma_f32_16x16x32_bf16 v[48:51], a[180:183], v[72:75], v[48:51]
  v_mfma_f32_16x16x32_bf16 v[56:59], a[244:247], v[72:75], v[56:59]
  v_mfma_f32_16x16x32_bf16 v[36:39], a[52:55], v[76:79], v[36:39]
  v_mfma_f32_16x16x32_bf16 v[44:47], a[116:119], v[76:79], v[44:47]
  v_mfma_f32_16x16x32_bf16 v[52:55], a[180:183], v[76:79], v[52:55]
  v_mfma_f32_16x16x32_bf16 v[60:63], a[244:247], v[76:79], v[60:63]
  s_waitcnt lgkmcnt(2)
  v_mfma_f32_16x16x32_bf16 v[32:35], a[56:59], v[80:83], v[32:35]
  v_mfma_f32_16x16x32_bf16 v[40:43], a[120:123], v[80:83], v[40:43]
  v_mfma_f32_16x16x32_bf16 v[48:51], a[184:187], v[80:83], v[48:51]
  s_add_u32 s55, s55, 32768
  v_mfma_f32_16x16x32_bf16 v[56:59], a[248:251], v[80:83], v[56:59]
  s_cmp_eq_u32 s55, 98304
  s_cselect_b32 s55, 0, s55
  v_mfma_f32_16x16x32_bf16 v[36:39], a[56:59], v[84:87], v[36:39]
  s_add_u32 s48, s47, s59
  v_mfma_f32_16x16x32_bf16 v[44:47], a[120:123], v[84:87], v[44:47]
  v_mfma_f32_16x16x32_bf16 v[52:55], a[184:187], v[84:87], v[52:55]
  v_mfma_f32_16x16x32_bf16 v[60:63], a[248:251], v[84:87], v[60:63]
  s_waitcnt lgkmcnt(0)
  v_mfma_f32_16x16x32_bf16 v[32:35], a[60:63], v[88:91], v[32:35]
  v_mfma_f32_16x16x32_bf16 v[40:43], a[124:127], v[88:91], v[40:43]
  v_mfma_f32_16x16x32_bf16 v[48:51], a[188:191], v[88:91], v[48:51]
  v_mfma_f32_16x16x32_bf16 v[56:59], a[252:255], v[88:91], v[56:59]
  v_mfma_f32_16x16x32_bf16 v[36:39], a[60:63], v[92:95], v[36:39]
  v_mfma_f32_16x16x32_bf16 v[44:47], a[124:127], v[92:95], v[44:47]
  v_mfma_f32_16x16x32_bf16 v[52:55], a[188:191], v[92:95], v[52:55]
  v_mfma_f32_16x16x32_bf16 v[60:63], a[252:255], v[92:95], v[60:63]
  v_add_u32 v20, s55, v16
  v_add_u32 v21, s55, v17
  v_add_u32 v22, s55, v18
  v_add_u32 v23, s55, v19
  s_barrier
  ds_read_b128 v[64:67], v20 offset:0
  ds_read_b128 v[68:71], v20 offset:16384
  ds_read_b128 v[72:75], v21 offset:0
  ds_read_b128 v[76:79], v21 offset:16384
  ds_read_b128 v[80:83], v22 offset:0
  ds_read_b128 v[84:87], v22 offset:16384
  v_max_f32 v32, 0, v32
  v_max_f32 v33, 0, v33
  v_max_f32 v34, 0, v34
  v_max_f32 v35, 0, v35
  v_mul_f32 v32, v32, v48
  v_mul_f32 v33, v33, v49
  v_mul_f32 v34, v34, v50
  v_mul_f32 v35, v35, v51
  v_cvt_pk_bf16_f32 v96, v32, v33
  v_cvt_pk_bf16_f32 v97, v34, v35
  v_max_f32 v40, 0, v40
  v_max_f32 v41, 0, v41
  v_max_f32 v42, 0, v42
  v_max_f32 v43, 0, v43
  v_mul_f32 v40, v40, v56
  v_mul_f32 v41, v41, v57
  v_mul_f32 v42, v42, v58
  v_mul_f32 v43, v43, v59
  v_cvt_pk_bf16_f32 v98, v40, v41
  v_cvt_pk_bf16_f32 v99, v42, v43
  buffer_store_dwordx4 v[96:99], v24, s[8:11], s47 offen sc1
  v_max_f32 v36, 0, v36
  v_max_f32 v37, 0, v37
  v_max_f32 v38, 0, v38
  v_max_f32 v39, 0, v39
  v_mul_f32 v36, v36, v52
  v_mul_f32 v37, v37, v53
  v_mul_f32 v38, v38, v54
  v_mul_f32 v39, v39, v55
  v_cvt_pk_bf16_f32 v100, v36, v37
  v_cvt_pk_bf16_f32 v101, v38, v39
  v_max_f32 v44, 0, v44
  v_max_f32 v45, 0, v45
  v_max_f32 v46, 0, v46
  v_max_f32 v47, 0, v47
  v_mul_f32 v44, v44, v60
  v_mul_f32 v45, v45, v61
  v_mul_f32 v46, v46, v62
  v_mul_f32 v47, v47, v63
  v_cvt_pk_bf16_f32 v102, v44, v45
  v_cvt_pk_bf16_f32 v103, v46, v47
  buffer_store_dwordx4 v[100:103], v24, s[8:11], s48 offen sc1
  s_add_u32 s47, s47, s49
  s_add_u32 s53, s53, 1
  s_cmp_lt_u32 s53, s54
  s_cbranch_scc1 L_A_loopF
L_A_fin:
  s_waitcnt vmcnt(0) lgkmcnt(0)
  s_add_u32 s36, s54, s30
  v_mov_b32 v26, s36
  s_mov_b64 exec, 1
  buffer_store_dwordx2 v[26:27], v25, s[8:11], s50 offen sc1
  s_mov_b64 exec, -1
  s_barrier
L_A_done:
  s_cmp_eq_u32 s27, 1
  s_cbranch_scc1 L_end
  s_load_dwordx2 s[80:81], s[0:1], 40
  s_load_dwordx4 s[84:87], s[0:1], 80
  s_load_dwordx2 s[88:89], s[0:1], 96
  s_and_b32 s36, s28, 15
  s_lshl_b32 s36, s36, 6
  s_lshr_b32 s63, s28, 4
  s_and_b32 s61, s26, 1
  s_lshr_b32 s62, s26, 1
  s_waitcnt lgkmcnt(0)
  s_lshl_b32 s37, s26, 20
  s_add_u32 s37, s37, s36
  s_add_u32 s38, s80, s37
  s_addc_u32 s39, s81, 0
  s_sub_u32 s37, 4194304, s37
  s_mov_b32 s12, s38
  s_and_b32 s13, s39, 0xffff
  s_mov_b32 s14, s37
  s_mov_b32 s15, 0x20000
  s_mul_i32 s37, s26, 458752
  s_add_u32 s37, s37, s36
  s_add_u32 s38, s84, s37
  s_addc_u32 s39, s85, 0
  s_sub_u32 s37, 1835008, s37
  s_mov_b32 s16, s38
  s_and_b32 s17, s39, 0xffff
  s_mov_b32 s18, s37
  s_mov_b32 s19, 0x20000
  s_mov_b32 s72, s86
  s_and_b32 s73, s87, 0xffff
  s_mov_b32 s74, 1024
  s_mov_b32 s75, 0x20000
  s_mov_b32 s20, s88
  s_and_b32 s21, s89, 0xffff
  s_mov_b32 s22, 2097152
  s_mov_b32 s23, 0x20000
  v_and_b32 v20, 15, v0
  v_lshrrev_b32 v21, 4, v0
  s_lshl_b32 s37, s26, 5
  s_add_u32 s36, s36, s37
  v_lshlrev_b32 v6, 10, v20
  v_lshl_add_u32 v6, v21, 3, v6
  v_add_u32 v6, s36, v6
  s_mov_b32 s43, 1024
  v_lshrrev_b32 v26, 2, v0
  v_mul_lo_u32 v22, v26, s43
  v_lshrrev_b32 v26, 4, v0
  v_lshrrev_b32 v27, 5, v0
  v_xor_b32 v26, v26, v27
  v_and_b32 v26, 1, v26
  v_lshlrev_b32 v26, 1, v26
  v_and_b32 v27, 3, v0
  v_xor_b32 v26, v26, v27
  v_lshl_add_u32 v22, v26, 4, v22
  s_mul_i32 s36, s26, 40960
  v_lshrrev_b32 v26, 4, v0
  v_bfe_u32 v27, v0, 2, 2
  v_lshl_add_u32 v27, v26, 2, v27
  v_lshrrev_b32 v23, 1, v26
  v_xor_b32 v26, v26, v23
  v_and_b32 v26, 1, v26
  v_lshlrev_b32 v23, 6, v27
  v_lshl_add_u32 v23, v26, 5, v23
  v_and_b32 v26, 3, v0
  v_lshl_add_u32 v23, v26, 3, v23
  v_add_u32 v23, s36, v23
  v_xor_b32 v24, 32, v23
  s_mul_i32 s44, s26, 40960
  s_and_b32 s36, s28, 1
  s_lshl_b32 s54, s63, 1
  s_or_b32 s54, s54, s36
  s_mov_b32 s54, 0
  s_lshl_b32 s56, s54, 17
  s_lshl_b32 s54, s54, 12
  s_add_u32 m0, s44, 0
  s_mov_b32 s42, 0
  buffer_load_dwordx4 v22, s[16:19], s42 offen  lds
  s_add_u32 m0, s44, 1024
  s_mov_b32 s42, 16384
  buffer_load_dwordx4 v22, s[16:19], s42 offen  lds
  s_add_u32 m0, s44, 2048
  s_mov_b32 s42, 32768
  buffer_load_dwordx4 v22, s[16:19], s42 offen  lds
  s_add_u32 m0, s44, 3072
  s_mov_b32 s42, 49152
  buffer_load_dwordx4 v22, s[16:19], s42 offen  lds
  s_add_u32 m0, s44, 4096
  s_mov_b32 s42, 65536
  buffer_load_dwordx4 v22, s[16:19], s42 offen  lds
  s_add_u32 m0, s44, 5120
  s_mov_b32 s42, 81920
  buffer_load_dwordx4 v22, s[16:19], s42 offen  lds
  s_add_u32 m0, s44, 6144
  s_mov_b32 s42, 98304
  buffer_load_dwordx4 v22, s[16:19], s42 offen  lds
  s_add_u32 m0, s44, 7168
  s_mov_b32 s42, 114688
  buffer_load_dwordx4 v22, s[16:19], s42 offen  lds
  s_waitcnt vmcnt(0)
  ds_read_b64_tr_b16 v[144:145], v23 offset:0
  ds_read_b64_tr_b16 v[146:147], v23 offset:1024
  ds_read_b64_tr_b16 v[200:201], v24 offset:0
  ds_read_b64_tr_b16 v[202:203], v24 offset:1024
  ds_read_b64_tr_b16 v[148:149], v23 offset:2048
  ds_read_b64_tr_b16 v[150:151], v23 offset:3072
  ds_read_b64_tr_b16 v[204:205], v24 offset:2048
  ds_read_b64_tr_b16 v[206:207], v24 offset:3072
  ds_read_b64_tr_b16 v[152:153], v23 offset:4096
  ds_read_b64_tr_b16 v[154:155], v23 offset:5120
  ds_read_b64_tr_b16 v[208:209], v24 offset:4096
  ds_read_b64_tr_b16 v[210:211], v24 offset:5120
  ds_read_b64_tr_b16 v[156:157], v23 offset:6144
  ds_read_b64_tr_b16 v[158:159], v23 offset:7168
  ds_read_b64_tr_b16 v[212:213], v24 offset:6144
  ds_read_b64_tr_b16 v[214:215], v24 offset:7168
  s_waitcnt lgkmcnt(0)
  s_add_u32 m0, s44, 0
  s_mov_b32 s42, 131072
  buffer_load_dwordx4 v22, s[16:19], s42 offen  lds
  s_add_u32 m0, s44, 1024
  s_mov_b32 s42, 147456
  buffer_load_dwordx4 v22, s[16:19], s42 offen  lds
  s_add_u32 m0, s44, 2048
  s_mov_b32 s42, 163840
  buffer_load_dwordx4 v22, s[16:19], s42 offen  lds
  s_add_u32 m0, s44, 3072
  s_mov_b32 s42, 180224
  buffer_load_dwordx4 v22, s[16:19], s42 offen  lds
  s_add_u32 m0, s44, 4096
  s_mov_b32 s42, 196608
  buffer_load_dwordx4 v22, s[16:19], s42 offen  lds
  s_add_u32 m0, s44, 5120
  s_mov_b32 s42, 212992
  buffer_load_dwordx4 v22, s[16:19], s42 offen  lds
  s_add_u32 m0, s44, 6144
  s_mov_b32 s42, 229376
  buffer_load_dwordx4 v22, s[16:19], s42 offen  lds
  s_add_u32 m0, s44, 7168
  s_mov_b32 s42, 245760
  buffer_load_dwordx4 v22, s[16:19], s42 offen  lds
  s_waitcnt vmcnt(0)
  ds_read_b64_tr_b16 v[160:161], v23 offset:0
  ds_read_b64_tr_b16 v[162:163], v23 offset:1024
  ds_read_b64_tr_b16 v[216:217], v24 offset:0
  ds_read_b64_tr_b16 v[218:219], v24 offset:1024
  ds_read_b64_tr_b16 v[164:165], v23 offset:2048
  ds_read_b64_tr_b16 v[166:167], v23 offset:3072
  ds_read_b64_tr_b16 v[220:221], v24 offset:2048
  ds_read_b64_tr_b16 v[222:223], v24 offset:3072
  ds_read_b64_tr_b16 v[168:169], v23 offset:4096
  ds_read_b64_tr_b16 v[170:171], v23 offset:5120
  ds_read_b64_tr_b16 v[224:225], v24 offset:4096
  ds_read_b64_tr_b16 v[226:227], v24 offset:5120
  ds_read_b64_tr_b16 v[172:173], v23 offset:6144
  ds_read_b64_tr_b16 v[174:175], v23 offset:7168
  ds_read_b64_tr_b16 v[228:229], v24 offset:6144
  ds_read_b64_tr_b16 v[230:231], v24 offset:7168
  s_waitcnt lgkmcnt(0)
  s_add_u32 m0, s44, 0
  s_mov_b32 s42, 262144
  buffer_load_dwordx4 v22, s[16:19], s42 offen  lds
  s_add_u32 m0, s44, 1024
  s_mov_b32 s42, 278528
  buffer_load_dwordx4 v22, s[16:19], s42 offen  lds
  s_add_u32 m0, s44, 2048
  s_mov_b32 s42, 294912
  buffer_load_dwordx4 v22, s[16:19], s42 offen  lds
  s_add_u32 m0, s44, 3072
  s_mov_b32 s42, 311296
  buffer_load_dwordx4 v22, s[16:19], s42 offen  lds
  s_add_u32 m0, s44, 4096
  s_mov_b32 s42, 327680
  buffer_load_dwordx4 v22, s[16:19], s42 offen  lds
  s_add_u32 m0, s44, 5120
  s_mov_b32 s42, 344064
  buffer_load_dwordx4 v22, s[16:19], s42 offen  lds
  s_add_u32 m0, s44, 6144
  s_mov_b32 s42, 360448
  buffer_load_dwordx4 v22, s[16:19], s42 offen  lds
  s_add_u32 m0, s44, 7168
  s_mov_b32 s42, 376832
  buffer_load_dwordx4 v22, s[16:19], s42 offen  lds
  s_waitcnt vmcnt(0)
  ds_read_b64_tr_b16 v[176:177], v23 offset:0
  ds_read_b64_tr_b16 v[178:179], v23 offset:1024
  ds_read_b64_tr_b16 v[232:233], v24 offset:0
  ds_read_b64_tr_b16 v[234:235], v24 offset:1024
  ds_read_b64_tr_b16 v[180:181], v23 offset:2048
  ds_read_b64_tr_b16 v[182:183], v23 offset:3072
  ds_read_b64_tr_b16 v[236:237], v24 offset:2048
  ds_read_b64_tr_b16 v[238:239], v24 offset:3072
  ds_read_b64_tr_b16 v[184:185], v23 offset:4096
  ds_read_b64_tr_b16 v[186:187], v23 offset:5120
  ds_read_b64_tr_b16 v[240:241], v24 offset:4096
  ds_read_b64_tr_b16 v[242:243], v24 offset:5120
  ds_read_b64_tr_b16 v[188:189], v23 offset:6144
  ds_read_b64_tr_b16 v[190:191], v23 offset:7168
  ds_read_b64_tr_b16 v[244:245], v24 offset:6144
  ds_read_b64_tr_b16 v[246:247], v24 offset:7168
  s_waitcnt lgkmcnt(0)
  s_add_u32 m0, s44, 0
  s_mov_b32 s42, 393216
  buffer_load_dwordx4 v22, s[16:19], s42 offen  lds
  s_add_u32 m0, s44, 1024
  s_mov_b32 s42, 409600
  buffer_load_dwordx4 v22, s[16:19], s42 offen  lds
  s_add_u32 m0, s44, 2048
  s_mov_b32 s42, 425984
  buffer_load_dwordx4 v22, s[16:19], s42 offen  lds
  s_add_u32 m0, s44, 3072
  s_mov_b32 s42, 442368
  buffer_load_dwordx4 v22, s[16:19], s42 offen  lds
  s_waitcnt vmcnt(0)
  ds_read_b64_tr_b16 v[192:193], v23 offset:0
  ds_read_b64_tr_b16 v[194:195], v23 offset:1024
  ds_read_b64_tr_b16 v[248:249], v24 offset:0
  ds_read_b64_tr_b16 v[250:251], v24 offset:1024
  ds_read_b64_tr_b16 v[196:197], v23 offset:2048
  ds_read_b64_tr_b16 v[198:199], v23 offset:3072
  ds_read_b64_tr_b16 v[252:253], v24 offset:2048
  ds_read_b64_tr_b16 v[254:255], v24 offset:3072
  s_waitcnt lgkmcnt(0)
  s_add_u32 m0, s44, 0
  s_xor_b32 s42, s56, 0
  buffer_load_dwordx4 v22, s[12:15], s42 offen  lds
  s_add_u32 m0, s44, 1024
  s_xor_b32 s42, s56, 16384
  buffer_load_dwordx4 v22, s[12:15], s42 offen  lds
  s_add_u32 m0, s44, 2048
  s_xor_b32 s42, s56, 32768
  buffer_load_dwordx4 v22, s[12:15], s42 offen  lds
  s_add_u32 m0, s44, 3072
  s_xor_b32 s42, s56, 49152
  buffer_load_dwordx4 v22, s[12:15], s42 offen  lds
  s_add_u32 m0, s44, 4096
  s_xor_b32 s42, s56, 65536
  buffer_load_dwordx4 v22, s[12:15], s42 offen  lds
  s_add_u32 m0, s44, 5120
  s_xor_b32 s42, s56, 81920
  buffer_load_dwordx4 v22, s[12:15], s42 offen  lds
  s_add_u32 m0, s44, 6144
  s_xor_b32 s42, s56, 98304
  buffer_load_dwordx4 v22, s[12:15], s42 offen  lds
  s_add_u32 m0, s44, 7168
  s_xor_b32 s42, s56, 114688
  buffer_load_dwordx4 v22, s[12:15], s42 offen  lds
  s_waitcnt vmcnt(0)
  ds_read_b64_tr_b16 a[0:1], v23 offset:0
  ds_read_b64_tr_b16 a[2:3], v23 offset:1024
  ds_read_b64_tr_b16 a[128:129], v24 offset:0
  ds_read_b64_tr_b16 a[130:131], v24 offset:1024
  ds_read_b64_tr_b16 a[4:5], v23 offset:2048
  ds_read_b64_tr_b16 a[6:7], v23 offset:3072
  ds_read_b64_tr_b16 a[132:133], v24 offset:2048
  ds_read_b64_tr_b16 a[134:135], v24 offset:3072
  ds_read_b64_tr_b16 a[8:9], v23 offset:4096
  ds_read_b64_tr_b16 a[10:11], v23 offset:5120
  ds_read_b64_tr_b16 a[136:137], v24 offset:4096
  ds_read_b64_tr_b16 a[138:139], v24 offset:5120
  ds_read_b64_tr_b16 a[12:13], v23 offset:6144
  ds_read_b64_tr_b16 a[14:15], v23 offset:7168
  ds_read_b64_tr_b16 a[140:141], v24 offset:6144
  ds_read_b64_tr_b16 a[142:143], v24 offset:7168
  s_waitcnt lgkmcnt(0)
  s_add_u32 m0, s44, 0
  s_xor_b32 s42, s56, 131072
  buffer_load_dwordx4 v22, s[12:15], s42 offen  lds
  s_add_u32 m0, s44, 1024
  s_xor_b32 s42, s56, 147456
  buffer_load_dwordx4 v22, s[12:15], s42 offen  lds
  s_add_u32 m0, s44, 2048
  s_xor_b32 s42, s56, 163840
  buffer_load_dwordx4 v22, s[12:15], s42 offen  lds
  s_add_u32 m0, s44, 3072
  s_xor_b32 s42, s56, 180224
  buffer_load_dwordx4 v22, s[12:15], s42 offen  lds
  s_add_u32 m0, s44, 4096
  s_xor_b32 s42, s56, 196608
  buffer_load_dwordx4 v22, s[12:15], s42 offen  lds
  s_add_u32 m0, s44, 5120
  s_xor_b32 s42, s56, 212992
  buffer_load_dwordx4 v22, s[12:15], s42 offen  lds
  s_add_u32 m0, s44, 6144
  s_xor_b32 s42, s56, 229376
  buffer_load_dwordx4 v22, s[12:15], s42 offen  lds
  s_add_u32 m0, s44, 7168
  s_xor_b32 s42, s56, 245760
  buffer_load_dwordx4 v22, s[12:15], s42 offen  lds
  s_waitcnt vmcnt(0)
  ds_read_b64_tr_b16 a[16:17], v23 offset:0
  ds_read_b64_tr_b16 a[18:19], v23 offset:1024
  ds_read_b64_tr_b16 a[144:145], v24 offset:0
  ds_read_b64_tr_b16 a[146:147], v24 offset:1024
  ds_read_b64_tr_b16 a[20:21], v23 offset:2048
  ds_read_b64_tr_b16 a[22:23], v23 offset:3072
  ds_read_b64_tr_b16 a[148:149], v24 offset:2048
  ds_read_b64_tr_b16 a[150:151], v24 offset:3072
  ds_read_b64_tr_b16 a[24:25], v23 offset:4096
  ds_read_b64_tr_b16 a[26:27], v23 offset:5120
  ds_read_b64_tr_b16 a[152:153], v24 offset:4096
  ds_read_b64_tr_b16 a[154:155], v24 offset:5120
  ds_read_b64_tr_b16 a[28:29], v23 offset:6144
  ds_read_b64_tr_b16 a[30:31], v23 offset:7168
  ds_read_b64_tr_b16 a[156:157], v24 offset:6144
  ds_read_b64_tr_b16 a[158:159], v24 offset:7168
  s_waitcnt lgkmcnt(0)
  s_add_u32 m0, s44, 0
  s_xor_b32 s42, s56, 262144
  buffer_load_dwordx4 v22, s[12:15], s42 offen  lds
  s_add_u32 m0, s44, 1024
  s_xor_b32 s42, s56, 278528
  buffer_load_dwordx4 v22, s[12:15], s42 offen  lds
  s_add_u32 m0, s44, 2048
  s_xor_b32 s42, s56, 294912
  buffer_load_dwordx4 v22, s[12:15], s42 offen  lds
  s_add_u32 m0, s44, 3072
  s_xor_b32 s42, s56, 311296
  buffer_load_dwordx4 v22, s[12:15], s42 offen  lds
  s_add_u32 m0, s44, 4096
  s_xor_b32 s42, s56, 327680
  buffer_load_dwordx4 v22, s[12:15], s42 offen  lds
  s_add_u32 m0, s44, 5120
  s_xor_b32 s42, s56, 344064
  buffer_load_dwordx4 v22, s[12:15], s42 offen  lds
  s_add_u32 m0, s44, 6144
  s_xor_b32 s42, s56, 360448
  buffer_load_dwordx4 v22, s[12:15], s42 offen  lds
  s_add_u32 m0, s44, 7168
  s_xor_b32 s42, s56, 376832
  buffer_load_dwordx4 v22, s[12:15], s42 offen  lds
  s_waitcnt vmcnt(0)
  ds_read_b64_tr_b16 a[32:33], v23 offset:0
  ds_read_b64_tr_b16 a[34:35], v23 offset:1024
  ds_read_b64_tr_b16 a[160:161], v24 offset:0
  ds_read_b64_tr_b16 a[162:163], v24 offset:1024
  ds_read_b64_tr_b16 a[36:37], v23 offset:2048
  ds_read_b64_tr_b16 a[38:39], v23 offset:3072
  ds_read_b64_tr_b16 a[164:165], v24 offset:2048
  ds_read_b64_tr_b16 a[166:167], v24 offset:3072
  ds_read_b64_tr_b16 a[40:41], v23 offset:4096
  ds_read_b64_tr_b16 a[42:43], v23 offset:5120
  ds_read_b64_tr_b16 a[168:169], v24 offset:4096
  ds_read_b64_tr_b16 a[170:171], v24 offset:5120
  ds_read_b64_tr_b16 a[44:45], v23 offset:6144
  ds_read_b64_tr_b16 a[46:47], v23 offset:7168
  ds_read_b64_tr_b16 a[172:173], v24 offset:6144
  ds_read_b64_tr_b16 a[174:175], v24 offset:7168
  s_waitcnt lgkmcnt(0)
  s_add_u32 m0, s44, 0
  s_xor_b32 s42, s56, 393216
  buffer_load_dwordx4 v22, s[12:15], s42 offen  lds
  s_add_u32 m0, s44, 1024
  s_xor_b32 s42, s56, 409600
  buffer_load_dwordx4 v22, s[12:15], s42 offen  lds
  s_add_u32 m0, s44, 2048
  s_xor_b32 s42, s56, 425984
  buffer_load_dwordx4 v22, s[12:15], s42 offen  lds
  s_add_u32 m0, s44, 3072
  s_xor_b32 s42, s56, 442368
  buffer_load_dwordx4 v22, s[12:15], s42 offen  lds
  s_add_u32 m0, s44, 4096
  s_xor_b32 s42, s56, 458752
  buffer_load_dwordx4 v22, s[12:15], s42 offen  lds
  s_add_u32 m0, s44, 5120
  s_xor_b32 s42, s56, 475136
  buffer_load_dwordx4 v22, s[12:15], s42 offen  lds
  s_add_u32 m0, s44, 6144
  s_xor_b32 s42, s56, 491520
  buffer_load_dwordx4 v22, s[12:15], s42 offen  lds
  s_add_u32 m0, s44, 7168
  s_xor_b32 s42, s56, 507904
  buffer_load_dwordx4 v22, s[12:15], s42 offen  lds
  s_waitcnt vmcnt(0)
  ds_read_b64_tr_b16 a[48:49], v23 offset:0
  ds_read_b64_tr_b16 a[50:51], v23 offset:1024
  ds_read_b64_tr_b16 a[176:177], v24 offset:0
  ds_read_b64_tr_b16 a[178:179], v24 offset:1024
  ds_read_b64_tr_b16 a[52:53], v23 offset:2048
  ds_read_b64_tr_b16 a[54:55], v23 offset:3072
  ds_read_b64_tr_b16 a[180:181], v24 offset:2048
  ds_read_b64_tr_b16 a[182:183], v24 offset:3072
  ds_read_b64_tr_b16 a[56:57], v23 offset:4096
  ds_read_b64_tr_b16 a[58:59], v23 offset:5120
  ds_read_b64_tr_b16 a[184:185], v24 offset:4096
  ds_read_b64_tr_b16 a[186:187], v24 offset:5120
  ds_read_b64_tr_b16 a[60:61], v23 offset:6144
  ds_read_b64_tr_b16 a[62:63], v23 offset:7168
  ds_read_b64_tr_b16 a[188:189], v24 offset:6144
  ds_read_b64_tr_b16 a[190:191], v24 offset:7168
  s_waitcnt lgkmcnt(0)
  s_add_u32 m0, s44, 0
  s_xor_b32 s42, s56, 524288
  buffer_load_dwordx4 v22, s[12:15], s42 offen  lds
  s_add_u32 m0, s44, 1024
  s_xor_b32 s42, s56, 540672
  buffer_load_dwordx4 v22, s[12:15], s42 offen  lds
  s_add_u32 m0, s44, 2048
  s_xor_b32 s42, s56, 557056
  buffer_load_dwordx4 v22, s[12:15], s42 offen  lds
  s_add_u32 m0, s44, 3072
  s_xor_b32 s42, s56, 573440
  buffer_load_dwordx4 v22, s[12:15], s42 offen  lds
  s_add_u32 m0, s44, 4096
  s_xor_b32 s42, s56, 589824
  buffer_load_dwordx4 v22, s[12:15], s42 offen  lds
  s_add_u32 m0, s44, 5120
  s_xor_b32 s42, s56, 606208
  buffer_load_dwordx4 v22, s[12:15], s42 offen  lds
  s_add_u32 m0, s44, 6144
  s_xor_b32 s42, s56, 622592
  buffer_load_dwordx4 v22, s[12:15], s42 offen  lds
  s_add_u32 m0, s44, 7168
  s_xor_b32 s42, s56, 638976
  buffer_load_dwordx4 v22, s[12:15], s42 offen  lds
  s_waitcnt vmcnt(0)
  ds_read_b64_tr_b16 a[64:65], v23 offset:0
  ds_read_b64_tr_b16 a[66:67], v23 offset:1024
  ds_read_b64_tr_b16 a[192:193], v24 offset:0
  ds_read_b64_tr_b16 a[194:195], v24 offset:1024
  ds_read_b64_tr_b16 a[68:69], v23 offset:2048
  ds_read_b64_tr_b16 a[70:71], v23 offset:3072
  ds_read_b64_tr_b16 a[196:197], v24 offset:2048
  ds_read_b64_tr_b16 a[198:199], v24 offset:3072
  ds_read_b64_tr_b16 a[72:73], v23 offset:4096
  ds_read_b64_tr_b16 a[74:75], v23 offset:5120
  ds_read_b64_tr_b16 a[200:201], v24 offset:4096
  ds_read_b64_tr_b16 a[202:203], v24 offset:5120
  ds_read_b64_tr_b16 a[76:77], v23 offset:6144
  ds_read_b64_tr_b16 a[78:79], v23 offset:7168
  ds_read_b64_tr_b16 a[204:205], v24 offset:6144
  ds_read_b64_tr_b16 a[206:207], v24 offset:7168
  s_waitcnt lgkmcnt(0)
  s_add_u32 m0, s44, 0
  s_xor_b32 s42, s56, 655360
  buffer_load_dwordx4 v22, s[12:15], s42 offen  lds
  s_add_u32 m0, s44, 1024
  s_xor_b32 s42, s56, 671744
  buffer_load_dwordx4 v22, s[12:15], s42 offen  lds
  s_add_u32 m0, s44, 2048
  s_xor_b32 s42, s56, 688128
  buffer_load_dwordx4 v22, s[12:15], s42 offen  lds
  s_add_u32 m0, s44, 3072
  s_xor_b32 s42, s56, 704512
  buffer_load_dwordx4 v22, s[12:15], s42 offen  lds
  s_add_u32 m0, s44, 4096
  s_xor_b32 s42, s56, 720896
  buffer_load_dwordx4 v22, s[12:15], s42 offen  lds
  s_add_u32 m0, s44, 5120
  s_xor_b32 s42, s56, 737280
  buffer_load_dwordx4 v22, s[12:15], s42 offen  lds
  s_add_u32 m0, s44, 6144
  s_xor_b32 s42, s56, 753664
  buffer_load_dwordx4 v22, s[12:15], s42 offen  lds
  s_add_u32 m0, s44, 7168
  s_xor_b32 s42, s56, 770048
  buffer_load_dwordx4 v22, s[12:15], s42 offen  lds
  s_waitcnt vmcnt(0)
  ds_read_b64_tr_b16 a[80:81], v23 offset:0
  ds_read_b64_tr_b16 a[82:83], v23 offset:1024
  ds_read_b64_tr_b16 a[208:209], v24 offset:0
  ds_read_b64_tr_b16 a[210:211], v24 offset:1024
  ds_read_b64_tr_b16 a[84:85], v23 offset:2048
  ds_read_b64_tr_b16 a[86:87], v23 offset:3072
  ds_read_b64_tr_b16 a[212:213], v24 offset:2048
  ds_read_b64_tr_b16 a[214:215], v24 offset:3072
  ds_read_b64_tr_b16 a[88:89], v23 offset:4096
  ds_read_b64_tr_b16 a[90:91], v23 offset:5120
  ds_read_b64_tr_b16 a[216:217], v24 offset:4096
  ds_read_b64_tr_b16 a[218:219], v24 offset:5120
  ds_read_b64_tr_b16 a[92:93], v23 offset:6144
  ds_read_b64_tr_b16 a[94:95], v23 offset:7168
  ds_read_b64_tr_b16 a[220:221], v24 offset:6144
  ds_read_b64_tr_b16 a[222:223], v24 offset:7168
  s_waitcnt lgkmcnt(0)
  s_add_u32 m0, s44, 0
  s_xor_b32 s42, s56, 786432
  buffer_load_dwordx4 v22, s[12:15], s42 offen  lds
  s_add_u32 m0, s44, 1024
  s_xor_b32 s42, s56, 802816
  buffer_load_dwordx4 v22, s[12:15], s42 offen  lds
  s_add_u32 m0, s44, 2048
  s_xor_b32 s42, s56, 819200
  buffer_load_dwordx4 v22, s[12:15], s42 offen  lds
  s_add_u32 m0, s44, 3072
  s_xor_b32 s42, s56, 835584
  buffer_load_dwordx4 v22, s[12:15], s42 offen  lds
  s_add_u32 m0, s44, 4096
  s_xor_b32 s42, s56, 851968
  buffer_load_dwordx4 v22, s[12:15], s42 offen  lds
  s_add_u32 m0, s44, 5120
  s_xor_b32 s42, s56, 868352
  buffer_load_dwordx4 v22, s[12:15], s42 offen  lds
  s_add_u32 m0, s44, 6144
  s_xor_b32 s42, s56, 884736
  buffer_load_dwordx4 v22, s[12:15], s42 offen  lds
  s_add_u32 m0, s44, 7168
  s_xor_b32 s42, s56, 901120
  buffer_load_dwordx4 v22, s[12:15], s42 offen  lds
  s_waitcnt vmcnt(0)
  ds_read_b64_tr_b16 a[96:97], v23 offset:0
  ds_read_b64_tr_b16 a[98:99], v23 offset:1024
  ds_read_b64_tr_b16 a[224:225], v24 offset:0
  ds_read_b64_tr_b16 a[226:227], v24 offset:1024
  ds_read_b64_tr_b16 a[100:101], v23 offset:2048
  ds_read_b64_tr_b16 a[102:103], v23 offset:3072
  ds_read_b64_tr_b16 a[228:229], v24 offset:2048
  ds_read_b64_tr_b16 a[230:231], v24 offset:3072
  ds_read_b64_tr_b16 a[104:105], v23 offset:4096
  ds_read_b64_tr_b16 a[106:107], v23 offset:5120
  ds_read_b64_tr_b16 a[232:233], v24 offset:4096
  ds_read_b64_tr_b16 a[234:235], v24 offset:5120
  ds_read_b64_tr_b16 a[108:109], v23 offset:6144
  ds_read_b64_tr_b16 a[110:111], v23 offset:7168
  ds_read_b64_tr_b16 a[236:237], v24 offset:6144
  ds_read_b64_tr_b16 a[238:239], v24 offset:7168
  s_waitcnt lgkmcnt(0)
  s_add_u32 m0, s44, 0
  s_xor_b32 s42, s56, 917504
  buffer_load_dwordx4 v22, s[12:15], s42 offen  lds
  s_add_u32 m0, s44, 1024
  s_xor_b32 s42, s56, 933888
  buffer_load_dwordx4 v22, s[12:15], s42 offen  lds
  s_add_u32 m0, s44, 2048
  s_xor_b32 s42, s56, 950272
  buffer_load_dwordx4 v22, s[12:15], s42 offen  lds
  s_add_u32 m0, s44, 3072
  s_xor_b32 s42, s56, 966656
  buffer_load_dwordx4 v22, s[12:15], s42 offen  lds
  s_add_u32 m0, s44, 4096
  s_xor_b32 s42, s56, 983040
  buffer_load_dwordx4 v22, s[12:15], s42 offen  lds
  s_add_u32 m0, s44, 5120
  s_xor_b32 s42, s56, 999424
  buffer_load_dwordx4 v22, s[12:15], s42 offen  lds
  s_add_u32 m0, s44, 6144
  s_xor_b32 s42, s56, 1015808
  buffer_load_dwordx4 v22, s[12:15], s42 offen  lds
  s_add_u32 m0, s44, 7168
  s_xor_b32 s42, s56, 1032192
  buffer_load_dwordx4 v22, s[12:15], s42 offen  lds
  s_waitcnt vmcnt(0)
  ds_read_b64_tr_b16 a[112:113], v23 offset:0
  ds_read_b64_tr_b16 a[114:115], v23 offset:1024
  ds_read_b64_tr_b16 a[240:241], v24 offset:0
  ds_read_b64_tr_b16 a[242:243], v24 offset:1024
  ds_read_b64_tr_b16 a[116:117], v23 offset:2048
  ds_read_b64_tr_b16 a[118:119], v23 offset:3072
  ds_read_b64_tr_b16 a[244:245], v24 offset:2048
  ds_read_b64_tr_b16 a[246:247], v24 offset:3072
  ds_read_b64_tr_b16 a[120:121], v23 offset:4096
  ds_read_b64_tr_b16 a[122:123], v23 offset:5120
  ds_read_b64_tr_b16 a[248:249], v24 offset:4096
  ds_read_b64_tr_b16 a[250:251], v24 offset:5120
  ds_read_b64_tr_b16 a[124:125], v23 offset:6144
  ds_read_b64_tr_b16 a[126:127], v23 offset:7168
  ds_read_b64_tr_b16 a[252:253], v24 offset:6144
  ds_read_b64_tr_b16 a[254:255], v24 offset:7168
  s_waitcnt lgkmcnt(0)
  v_mov_b32 v10, 208
L_nonce_3:
  s_sub_u32 s100, s100, 1
  s_cbranch_scc1 L_end
  global_load_dwordx2 v[8:9], v10, s[24:25] sc1
  s_waitcnt vmcnt(0)
L_nonce_4:
  v_readfirstlane_b32 s30, v8
  v_readfirstlane_b32 s31, v9
  s_mul_i32 s36, s30, 0x9E3779B1
  s_or_b32 s36, s36, 1
  s_cmp_eq_u32 s36, s31
  s_cbranch_scc0 L_nonce_3
  s_barrier
  v_lshlrev_b32 v1, 4, v0
  v_lshlrev_b32 v2, 3, v0
  v_lshlrev_b32 v15, 7, v0
  v_and_b32 v44, 15, v0
  v_lshrrev_b32 v45, 4, v0
  s_lshl_b32 s36, s26, 12
  s_add_u32 s36, s36, 65536
  v_add_u32 v13, s36, v2
  v_lshlrev_b32 v46, 3, v45
  v_lshl_add_u32 v46, v44, 5, v46
  s_lshl_b32 s37, s62, 11
  s_add_u32 s36, s36, s37
  v_add_u32 v3, s36, v46
  v_add_u32 v4, s37, v1
  s_lshl_b32 s36, s26, 8
  v_lshlrev_b32 v14, 4, v45
  v_add_u32 v14, s36, v14
  v_lshl_add_u32 v5, v44, 10, v14
  v_mov_b32 v7, 0
  v_mov_b32 v11, s31
  v_mov_b32 v28, 0x3f803f80
  v_mov_b32 v29, 0x3f803f80
  v_mov_b32 v30, 0x3f803f80
  v_mov_b32 v31, 0x3f803f80
  s_lshl_b32 s36, s61, 4
  v_add_u32 v46, s36, v44
  v_lshlrev_b32 v47, 2, v45
  v_sub_u32 v46, v46, v47
  v_mov_b32 v47, 0xff800000
  v_cmp_le_i32 vcc, 0, v46
  s_nop 1
  v_cndmask_b32 v16, v47, v7, vcc
  v_cmp_le_i32 vcc, 1, v46
  s_nop 1
  v_cndmask_b32 v17, v47, v7, vcc
  v_cmp_le_i32 vcc, 2, v46
  s_nop 1
  v_cndmask_b32 v18, v47, v7, vcc
  v_cmp_le_i32 vcc, 3, v46
  s_nop 1
  v_cndmask_b32 v19, v47, v7, vcc
  v_cmp_le_i32 vcc, 16, v46
  s_nop 1
  v_cndmask_b32 v20, v47, v7, vcc
  v_cmp_le_i32 vcc, 17, v46
  s_nop 1
  v_cndmask_b32 v21, v47, v7, vcc
  v_cmp_le_i32 vcc, 18, v46
  s_nop 1
  v_cndmask_b32 v22, v47, v7, vcc
  v_cmp_le_i32 vcc, 19, v46
  s_nop 1
  v_cndmask_b32 v23, v47, v7, vcc
  v_mov_b32 v24, 0
  v_mov_b32 v25, 0
  v_mov_b32 v26, 0
  v_mov_b32 v27, 0
  s_mov_b32 s45, 0x3e0293ee
  s_mov_b32 s46, 0xbe0293ee
  s_lshl_b32 s47, s28, 8
  s_add_u32 s47, s47, 85983232
  s_lshl_b32 s36, s27, 2
  s_lshr_b32 s40, 0x51430200, s36
  s_and_b32 s40, s40, 15
  s_mov_b32 s41, 0
  s_mov_b32 s64, 0
  s_mov_b32 s57, 20
  s_mov_b32 s52, 21
  s_branch L_wf_6
L_wf_5:
  s_sleep 16
  s_sub_u32 s100, s100, 1
  s_cbranch_scc1 L_end
L_wf_6:
  buffer_load_dwordx2 v[8:9], v2, s[8:11], s47 offen sc1
  s_waitcnt vmcnt(0)
  v_cmp_eq_u32 s[66:67], v11, v9
  s_add_u32 s42, s57, s30
  s_add_u32 s42, s42, 1
  v_subrev_u32 v12, s42, v8
  v_cmp_gt_u32 vcc, 64, v12
  s_nop 0
  s_and_b32 s42, s66, vcc_lo
  s_andn2_b32 s42, 0x666666, s42
  s_cbranch_scc1 L_wf_5
  s_add_u32 s42, s52, s30
  s_add_u32 s42, s42, 1
  v_subrev_u32 v12, s42, v8
  v_cmp_gt_u32 vcc, 64, v12
  s_nop 0
  s_and_b32 s42, s66, vcc_lo
  s_andn2_b32 s42, 0x111111, s42
  s_cbranch_scc1 L_wf_5
  s_mul_i32 s48, s26, 112
  s_add_u32 s48, s48, 85999616
  s_branch L_wf_8
L_wf_7:
  s_sleep 16
  s_sub_u32 s100, s100, 1
  s_cbranch_scc1 L_end
L_wf_8:
  buffer_load_dwordx2 v[8:9], v2, s[8:11], s48 offen sc1
  s_waitcnt vmcnt(0)
  v_cmp_eq_u32 s[66:67], v11, v9
  s_add_u32 s42, s52, s30
  s_add_u32 s42, s42, 1
  v_subrev_u32 v12, s42, v8
  v_cmp_gt_u32 vcc, 64, v12
  s_nop 0
  s_and_b32 s42, s66, vcc_lo
  s_andn2_b32 s42, 0x3fff, s42
  s_cbranch_scc1 L_wf_7
  s_mul_i32 s48, s26, 112
  s_add_u32 s48, s48, 86000128
  s_branch L_wf_10
L_wf_9:
  s_sleep 16
  s_sub_u32 s100, s100, 1
  s_cbranch_scc1 L_end
L_wf_10:
  buffer_load_dwordx2 v[8:9], v2, s[8:11], s48 offen sc1
  s_waitcnt vmcnt(0)
  v_cmp_eq_u32 s[66:67], v11, v9
  s_add_u32 s42, s57, s30
  s_add_u32 s42, s42, 1
  v_subrev_u32 v12, s42, v8
  v_cmp_gt_u32 vcc, 64, v12
  s_nop 0
  s_and_b32 s42, s66, vcc_lo
  s_andn2_b32 s42, 0x3fff, s42
  s_cbranch_scc1 L_wf_9
  s_mul_i32 s48, s26, 112
  s_add_u32 s48, s48, 86000640
  s_branch L_wf_12
L_wf_11:
  s_sleep 16
  s_sub_u32 s100, s100, 1
  s_cbranch_scc1 L_end
L_wf_12:
  buffer_load_dwordx2 v[8:9], v2, s[8:11], s48 offen sc1
  s_waitcnt vmcnt(0)
  v_cmp_eq_u32 s[66:67], v11, v9
  s_add_u32 s42, s57, s30
  s_add_u32 s42, s42, 1
  v_subrev_u32 v12, s42, v8
  v_cmp_gt_u32 vcc, 64, v12
  s_nop 0
  s_and_b32 s42, s66, vcc_lo
  s_andn2_b32 s42, 0x3fff, s42
  s_cbranch_scc1 L_wf_11
  v_and_b32 v46, 3, v0
  v_cmp_eq_u32 vcc, 0, v46
  s_nop 1
  v_cndmask_b32_e64 v44, 21, 22, vcc
  v_min_u32 v46, 2, v46
  v_add_u32 v44, s30, v44
  v_and_b32 v45, 4, v0
  v_add_u32 v46, v46, v45
  v_lshlrev_b32 v46, 3, v46
  v_lshrrev_b32 v45, 3, v0
  v_lshl_add_u32 v46, v45, 8, v46
  s_lshl_b32 s36, s26, 11
  s_lshl_b32 s37, s63, 7
  s_add_u32 s36, s36, s37
  s_add_u32 s36, s36, 85983232
  s_branch L_B_w2a
L_B_w2:
  s_sleep 16
  s_sub_u32 s100, s100, 1
  s_cbranch_scc1 L_end
L_B_w2a:
  buffer_load_dwordx2 v[8:9], v46, s[8:11], s36 offen sc1
  s_waitcnt vmcnt(0)
  v_cmp_ne_u32 vcc, v44, v8
  v_cmp_ne_u32 s[66:67], v11, v9
  s_nop 0
  s_or_b64 vcc, vcc, s[66:67]
  s_cbranch_scc1 L_B_w2
  s_mul_i32 s36, s27, 24
  s_sub_u32 s36, s36, 24
  v_mov_b32 v46, s36
L_B_w3:
  s_sub_u32 s100, s100, 1
  s_cbranch_scc1 L_end
  global_load_dword v47, v46, s[24:25] sc1
  s_waitcnt vmcnt(0)
  v_readfirstlane_b32 s36, v47
  s_nop 0
  s_and_b32 s37, s36, 0xffff
  s_cmp_lt_u32 s37, 32
  s_cbranch_scc1 L_B_w3
  s_lshr_b32 s29, s36, 16
  v_lshlrev_b32 v15, 10, v0
  v_xor_b32 v10, 2048, v4
  v_xor_b32 v11, 2048, v3
L_B_loop:
  s_lshl_b32 s36, s40, 1
  s_add_u32 s36, s36, s63
  s_lshl_b32 s65, s36, 14
  s_lshl_b32 s60, s36, 17
  s_mul_i32 s48, s36, 57344
  s_mul_i32 s37, s26, 14336
  s_add_u32 s48, s48, s37
  s_add_u32 s48, s48, 67108864
  s_cmp_lt_u32 s40, 58
  s_cbranch_scc1 L_B_h0
  buffer_load_dwordx4 v[108:111], v5, s[4:7], s65 offen offset:0
  buffer_load_dwordx4 v[124:127], v14, s[72:75], 0 offen offset:0
  buffer_load_dwordx4 v[112:115], v5, s[4:7], s65 offen offset:64
  buffer_load_dwordx4 v[128:131], v14, s[72:75], 0 offen offset:64
  buffer_load_dwordx4 v[116:119], v5, s[4:7], s65 offen offset:128
  buffer_load_dwordx4 v[132:135], v14, s[72:75], 0 offen offset:128
  buffer_load_dwordx4 v[120:123], v5, s[4:7], s65 offen offset:192
  buffer_load_dwordx4 v[136:139], v14, s[72:75], 0 offen offset:192
  buffer_load_dwordx4 v[52:55], v1, s[8:11], s48 offen offset:0 sc1
  buffer_load_dwordx4 v[56:59], v1, s[8:11], s48 offen offset:1024 sc1
  buffer_load_dwordx4 v[60:63], v1, s[8:11], s48 offen offset:2048 sc1
  buffer_load_dwordx4 v[64:67], v1, s[8:11], s48 offen offset:3072 sc1
  s_add_u32 s48, s48, 4096
  buffer_load_dwordx4 v[68:71], v1, s[8:11], s48 offen offset:0 sc1
  buffer_load_dwordx4 v[72:75], v1, s[8:11], s48 offen offset:1024 sc1
  buffer_load_dwordx4 v[76:79], v1, s[8:11], s48 offen offset:2048 sc1
  buffer_load_dwordx4 v[80:83], v1, s[8:11], s48 offen offset:3072 sc1
  s_add_u32 s48, s48, 4096
  buffer_load_dwordx4 v[84:87], v1, s[8:11], s48 offen offset:0 sc1
  buffer_load_dwordx4 v[88:91], v1, s[8:11], s48 offen offset:1024 sc1
  buffer_load_dwordx4 v[92:95], v1, s[8:11], s48 offen offset:2048 sc1
  buffer_load_dwordx4 v[96:99], v1, s[8:11], s48 offen offset:3072 sc1
  s_add_u32 s48, s48, 4096
  buffer_load_dwordx4 v[100:103], v1, s[8:11], s48 offen offset:0 sc1
  buffer_load_dwordx4 v[104:107], v1, s[8:11], s48 offen offset:1024 sc1
  s_waitcnt vmcnt(14)
  v_mfma_f32_16x16x32_bf16 v[40:43], v[124:127], v[108:111], 0
  v_mfma_f32_16x16x32_bf16 v[40:43], v[128:131], v[112:115], v[40:43]
  v_mfma_f32_16x16x32_bf16 v[40:43], v[132:135], v[116:119], v[40:43]
  v_mfma_f32_16x16x32_bf16 v[40:43], v[136:139], v[120:123], v[40:43]
  s_waitcnt vmcnt(13)
  v_mfma_f32_16x16x32_bf16 v[32:35], v[144:147], v[52:55], 0
  v_mfma_f32_16x16x32_bf16 v[36:39], v[200:203], v[52:55], 0
  s_waitcnt vmcnt(12)
  v_mfma_f32_16x16x32_bf16 v[32:35], v[148:151], v[56:59], v[32:35]
  v_mfma_f32_16x16x32_bf16 v[36:39], v[204:207], v[56:59], v[36:39]
  s_waitcnt vmcnt(11)
  v_mfma_f32_16x16x32_bf16 v[32:35], v[152:155], v[60:63], v[32:35]
  v_mfma_f32_16x16x32_bf16 v[36:39], v[208:211], v[60:63], v[36:39]
  s_waitcnt vmcnt(10)
  v_mfma_f32_16x16x32_bf16 v[32:35], v[156:159], v[64:67], v[32:35]
  v_mfma_f32_16x16x32_bf16 v[36:39], v[212:215], v[64:67], v[36:39]
  s_waitcnt vmcnt(9)
  v_mfma_f32_16x16x32_bf16 v[32:35], v[160:163], v[68:71], v[32:35]
  v_mfma_f32_16x16x32_bf16 v[36:39], v[216:219], v[68:71], v[36:39]
  s_waitcnt vmcnt(8)
  v_mfma_f32_16x16x32_bf16 v[32:35], v[164:167], v[72:75], v[32:35]
  v_mfma_f32_16x16x32_bf16 v[36:39], v[220:223], v[72:75], v[36:39]
  s_waitcnt vmcnt(7)
  v_mfma_f32_16x16x32_bf16 v[32:35], v[168:171], v[76:79], v[32:35]
  v_mfma_f32_16x16x32_bf16 v[36:39], v[224:227], v[76:79], v[36:39]
  s_waitcnt vmcnt(6)
  v_mfma_f32_16x16x32_bf16 v[32:35], v[172:175], v[80:83], v[32:35]
  v_mfma_f32_16x16x32_bf16 v[36:39], v[228:231], v[80:83], v[36:39]
  s_waitcnt vmcnt(5)
  v_mfma_f32_16x16x32_bf16 v[32:35], v[176:179], v[84:87], v[32:35]
  v_mfma_f32_16x16x32_bf16 v[36:39], v[232:235], v[84:87], v[36:39]
  s_waitcnt vmcnt(4)
  v_mfma_f32_16x16x32_bf16 v[32:35], v[180:183], v[88:91], v[32:35]
  v_mfma_f32_16x16x32_bf16 v[36:39], v[236:239], v[88:91], v[36:39]
  s_waitcnt vmcnt(3)
  v_mfma_f32_16x16x32_bf16 v[32:35], v[184:187], v[92:95], v[32:35]
  v_mfma_f32_16x16x32_bf16 v[36:39], v[240:243], v[92:95], v[36:39]
  s_waitcnt vmcnt(2)
  v_mfma_f32_16x16x32_bf16 v[32:35], v[188:191], v[96:99], v[32:35]
  v_mfma_f32_16x16x32_bf16 v[36:39], v[244:247], v[96:99], v[36:39]
  s_waitcnt vmcnt(1)
  v_mfma_f32_16x16x32_bf16 v[32:35], v[192:195], v[100:103], v[32:35]
  v_mfma_f32_16x16x32_bf16 v[36:39], v[248:251], v[100:103], v[36:39]
  s_waitcnt vmcnt(0)
  v_mfma_f32_16x16x32_bf16 v[32:35], v[196:199], v[104:107], v[32:35]
  v_mfma_f32_16x16x32_bf16 v[36:39], v[252:255], v[104:107], v[36:39]
L_B_h0:
  s_lshl_b32 s36, s40, 5
  s_add_u32 s36, s36, s28
  s_lshl_b32 s59, s36, 14
  s_lshl_b32 s58, s36, 13
  s_lshl_b32 s37, s61, 12
  s_add_u32 s58, s58, s37
  s_add_u32 s58, s58, 33554432
  s_lshl_b32 s43, s36, 12
  s_add_u32 s43, s43, 75497472
  buffer_load_dwordx4 v[44:47], v1, s[8:11], s58 offen offset:0 sc1
  buffer_load_dwordx4 v[48:51], v1, s[8:11], s58 offen offset:1024 sc1
  buffer_load_dwordx4 v[52:55], v1, s[8:11], s58 offen offset:2048 sc1
  buffer_load_dwordx4 v[56:59], v1, s[8:11], s58 offen offset:3072 sc1
  buffer_load_dwordx4 v[60:63], v1, s[8:11], s59 offen offset:0 sc1
  buffer_load_dwordx4 v[64:67], v1, s[8:11], s59 offen offset:1024 sc1
  buffer_load_dwordx4 v[68:71], v1, s[8:11], s59 offen offset:2048 sc1
  buffer_load_dwordx4 v[72:75], v1, s[8:11], s59 offen offset:3072 sc1
  s_add_u32 s36, s59, 4096
  buffer_load_dwordx4 v[76:79], v1, s[8:11], s36 offen offset:0 sc1
  buffer_load_dwordx4 v[80:83], v1, s[8:11], s36 offen offset:1024 sc1
  buffer_load_dwordx4 v[84:87], v1, s[8:11], s36 offen offset:2048 sc1
  buffer_load_dwordx4 v[88:91], v1, s[8:11], s36 offen offset:3072 sc1
  s_lshl_b32 s37, s62, 12
  s_add_u32 s36, s36, s37
  s_add_u32 s36, s36, 4096
  buffer_load_dwordx4 v[92:95], v1, s[8:11], s36 offen offset:0 sc1
  buffer_load_dwordx4 v[96:99], v1, s[8:11], s36 offen offset:1024 sc1
  buffer_load_dwordx4 v[100:103], v1, s[8:11], s36 offen offset:2048 sc1
  buffer_load_dwordx4 v[104:107], v1, s[8:11], s36 offen offset:3072 sc1
  buffer_load_dwordx4 v[120:123], v4, s[8:11], s43 offen offset:0 sc1
  buffer_load_dwordx4 v[124:127], v4, s[8:11], s43 offen offset:1024 sc1
  buffer_load_dwordx4 v[128:131], v10, s[8:11], s43 offen offset:0 sc1
  buffer_load_dwordx4 v[132:135], v10, s[8:11], s43 offen offset:1024 sc1
  s_waitcnt vmcnt(12)
  v_mfma_f32_16x16x32_bf16 v[108:111], v[60:63], v[44:47], v[16:19]
  v_mfma_f32_16x16x32_bf16 v[108:111], v[64:67], v[48:51], v[108:111]
  v_mfma_f32_16x16x32_bf16 v[108:111], v[68:71], v[52:55], v[108:111]
  v_mfma_f32_16x16x32_bf16 v[108:111], v[72:75], v[56:59], v[108:111]
  s_waitcnt vmcnt(8)
  v_mfma_f32_16x16x32_bf16 v[112:115], v[76:79], v[44:47], v[20:23]
  v_mfma_f32_16x16x32_bf16 v[112:115], v[80:83], v[48:51], v[112:115]
  v_mfma_f32_16x16x32_bf16 v[112:115], v[84:87], v[52:55], v[112:115]
  v_mfma_f32_16x16x32_bf16 v[112:115], v[88:91], v[56:59], v[112:115]
  s_lshl_b32 s36, s40, 1
  s_add_u32 s36, s36, s61
  s_lshl_b32 s36, s36, 17
  s_lshl_b32 s37, s28, 12
  s_add_u32 s36, s36, s37
  s_lshl_b32 s37, s62, 11
  s_add_u32 s36, s36, s37
  s_add_u32 s36, s36, 50331648
  v_max3_f32 v136, v108, v109, v110
  v_max3_f32 v136, v111, v112, v136
  v_max3_f32 v136, v113, v114, v136
  s_branch L_B_km1
L_B_km0:
  s_sleep 1
  s_cmp_ge_u32 s40, 58
  s_cbranch_scc1 L_B_km2
  s_sleep 40
L_B_km2:
  s_sub_u32 s100, s100, 1
  s_cbranch_scc1 L_end
  buffer_load_dwordx4 v[120:123], v4, s[8:11], s43 offen offset:0 sc1
  buffer_load_dwordx4 v[124:127], v4, s[8:11], s43 offen offset:1024 sc1
  buffer_load_dwordx4 v[128:131], v10, s[8:11], s43 offen offset:0 sc1
  buffer_load_dwordx4 v[132:135], v10, s[8:11], s43 offen offset:1024 sc1
L_B_km1:
  s_waitcnt vmcnt(3)
  ds_write2st64_b32 v3, v120, v121 offset0:0 offset1:2
  v_max3_u32 v12, v120, v121, v122
  v_max_u32 v12, v123, v12
  s_waitcnt vmcnt(2)
  ds_write2st64_b32 v3, v124, v125 offset0:4 offset1:6
  v_max3_u32 v12, v124, v125, v12
  v_max3_u32 v12, v126, v127, v12
  s_waitcnt vmcnt(1)
  ds_write2st64_b32 v11, v128, v129 offset0:0 offset1:2
  v_max3_u32 v12, v128, v129, v12
  v_max3_u32 v12, v130, v131, v12
  s_waitcnt vmcnt(0)
  ds_write2st64_b32 v11, v132, v133 offset0:4 offset1:6
  v_max3_u32 v12, v132, v133, v12
  v_max3_u32 v12, v134, v135, v12
  v_cmp_eq_u32 vcc, -1, v12
  s_cbranch_vccnz L_B_km0
  s_waitcnt lgkmcnt(0)
  ds_read_b64_tr_b16 v[76:77], v13 offset:0
  ds_read_b64_tr_b16 v[78:79], v13 offset:512
  ds_read_b64_tr_b16 v[80:81], v13 offset:1024
  ds_read_b64_tr_b16 v[82:83], v13 offset:1536
  ds_read_b64_tr_b16 v[84:85], v13 offset:2048
  ds_read_b64_tr_b16 v[86:87], v13 offset:2560
  ds_read_b64_tr_b16 v[88:89], v13 offset:3072
  ds_read_b64_tr_b16 v[90:91], v13 offset:3584
  s_waitcnt lgkmcnt(6)
  v_mfma_f32_16x16x32_bf16 v[116:119], v[76:79], v[44:47], 0
  s_waitcnt lgkmcnt(4)
  v_mfma_f32_16x16x32_bf16 v[116:119], v[80:83], v[48:51], v[116:119]
  s_waitcnt lgkmcnt(2)
  v_mfma_f32_16x16x32_bf16 v[116:119], v[84:87], v[52:55], v[116:119]
  s_waitcnt lgkmcnt(0)
  v_mfma_f32_16x16x32_bf16 v[116:119], v[88:91], v[56:59], v[116:119]
  s_nop 7
  v_max3_f32 v136, v115, v116, v136
  v_max_f32 v136, v117, v136
  v_mov_b32 v137, v136
  s_nop 1
  v_permlane16_swap_b32 v136, v137
  v_max_f32 v136, v136, v137
  v_mov_b32 v137, v136
  s_nop 1
  v_permlane32_swap_b32 v136, v137
  v_max_f32 v136, v136, v137
  v_mul_f32 v136, s46, v136
  v_fma_f32 v108, v108, s45, v136
  v_fma_f32 v109, v109, s45, v136
  v_fma_f32 v110, v110, s45, v136
  v_fma_f32 v111, v111, s45, v136
  v_fma_f32 v112, v112, s45, v136
  v_fma_f32 v113, v113, s45, v136
  v_fma_f32 v114, v114, s45, v136
  v_fma_f32 v115, v115, s45, v136
  v_fma_f32 v116, v116, s45, v136
  v_fma_f32 v117, v117, s45, v136
  v_exp_f32 v108, v108
  v_exp_f32 v109, v109
  v_exp_f32 v110, v110
  v_exp_f32 v111, v111
  v_exp_f32 v112, v112
  v_exp_f32 v113, v113
  v_exp_f32 v114, v114
  v_exp_f32 v115, v115
  v_exp_f32 v116, v116
  v_exp_f32 v117, v117
  v_cvt_pk_bf16_f32 v60, v108, v109
  v_cvt_pk_bf16_f32 v61, v110, v111
  v_cvt_pk_bf16_f32 v62, v112, v113
  v_cvt_pk_bf16_f32 v63, v114, v115
  v_cvt_pk_bf16_f32 v24, v116, v117
  v_cvt_pk_bf16_f32 v27, v116, v117
  s_waitcnt vmcnt(0)
  v_mfma_f32_16x16x32_bf16 v[68:71], v[28:31], v[60:63], 0
  v_mfma_f32_16x16x32_bf16 v[76:79], v[92:95], v[60:63], 0
  v_mfma_f32_16x16x32_bf16 v[80:83], v[96:99], v[60:63], 0
  v_mfma_f32_16x16x32_bf16 v[84:87], v[100:103], v[60:63], 0
  v_mfma_f32_16x16x32_bf16 v[88:91], v[104:107], v[60:63], 0
  s_nop 1
  v_mfma_f32_16x16x16_bf16 v[68:71], v[28:29], v[24:25], v[68:71]
  v_mfma_f32_16x16x16_bf16 v[76:79], v[122:123], v[24:25], v[76:79]
  v_mfma_f32_16x16x16_bf16 v[80:83], v[122:123], v[26:27], v[80:83]
  v_mfma_f32_16x16x16_bf16 v[84:87], v[126:127], v[24:25], v[84:87]
  v_mfma_f32_16x16x16_bf16 v[88:91], v[126:127], v[26:27], v[88:91]
  s_nop 3
  v_rcp_f32 v68, v68
  s_nop 0
  v_mul_f32 v76, v76, v68
  v_mul_f32 v77, v77, v68
  v_mul_f32 v78, v78, v68
  v_mul_f32 v79, v79, v68
  v_mul_f32 v80, v80, v68
  v_mul_f32 v81, v81, v68
  v_mul_f32 v82, v82, v68
  v_mul_f32 v83, v83, v68
  v_cvt_pk_bf16_f32 v44, v76, v77
  v_cvt_pk_bf16_f32 v45, v78, v79
  v_cvt_pk_bf16_f32 v46, v80, v81
  v_cvt_pk_bf16_f32 v47, v82, v83
  v_mul_f32 v84, v84, v68
  v_mul_f32 v85, v85, v68
  v_mul_f32 v86, v86, v68
  v_mul_f32 v87, v87, v68
  v_mul_f32 v88, v88, v68
  v_mul_f32 v89, v89, v68
  v_mul_f32 v90, v90, v68
  v_mul_f32 v91, v91, v68
  v_cvt_pk_bf16_f32 v48, v84, v85
  v_cvt_pk_bf16_f32 v49, v86, v87
  v_cvt_pk_bf16_f32 v50, v88, v89
  v_cvt_pk_bf16_f32 v51, v90, v91
  s_cmp_lg_u32 s29, 0
  s_cbranch_scc1 L_B_ox
  s_sub_u32 s37, s40, 18
  s_cmp_lt_u32 s37, 40
  s_cbranch_scc1 L_B_ox
  buffer_store_dwordx4 v[44:47], v1, s[8:11], s36 offen offset:0
  buffer_store_dwordx4 v[48:51], v1, s[8:11], s36 offen offset:1024
  s_branch L_B_od
L_B_ox:
  buffer_store_dwordx4 v[44:47], v1, s[8:11], s36 offen offset:0 sc1
  buffer_store_dwordx4 v[48:51], v1, s[8:11], s36 offen offset:1024 sc1
L_B_od:
  s_cmp_ge_u32 s40, 58
  s_cbranch_scc1 L_B_h1
  buffer_load_dwordx4 v[108:111], v5, s[4:7], s65 offen offset:0
  buffer_load_dwordx4 v[124:127], v14, s[72:75], 0 offen offset:0
  buffer_load_dwordx4 v[112:115], v5, s[4:7], s65 offen offset:64
  buffer_load_dwordx4 v[128:131], v14, s[72:75], 0 offen offset:64
  buffer_load_dwordx4 v[116:119], v5, s[4:7], s65 offen offset:128
  buffer_load_dwordx4 v[132:135], v14, s[72:75], 0 offen offset:128
  buffer_load_dwordx4 v[120:123], v5, s[4:7], s65 offen offset:192
  buffer_load_dwordx4 v[136:139], v14, s[72:75], 0 offen offset:192
  buffer_load_dwordx4 v[52:55], v1, s[8:11], s48 offen offset:0 sc1
  buffer_load_dwordx4 v[56:59], v1, s[8:11], s48 offen offset:1024 sc1
  buffer_load_dwordx4 v[60:63], v1, s[8:11], s48 offen offset:2048 sc1
  buffer_load_dwordx4 v[64:67], v1, s[8:11], s48 offen offset:3072 sc1
  s_add_u32 s48, s48, 4096
  buffer_load_dwordx4 v[68:71], v1, s[8:11], s48 offen offset:0 sc1
  buffer_load_dwordx4 v[72:75], v1, s[8:11], s48 offen offset:1024 sc1
  buffer_load_dwordx4 v[76:79], v1, s[8:11], s48 offen offset:2048 sc1
  buffer_load_dwordx4 v[80:83], v1, s[8:11], s48 offen offset:3072 sc1
  s_add_u32 s48, s48, 4096
  buffer_load_dwordx4 v[84:87], v1, s[8:11], s48 offen offset:0 sc1
  buffer_load_dwordx4 v[88:91], v1, s[8:11], s48 offen offset:1024 sc1
  buffer_load_dwordx4 v[92:95], v1, s[8:11], s48 offen offset:2048 sc1
  buffer_load_dwordx4 v[96:99], v1, s[8:11], s48 offen offset:3072 sc1
  s_add_u32 s48, s48, 4096
  buffer_load_dwordx4 v[100:103], v1, s[8:11], s48 offen offset:0 sc1
  buffer_load_dwordx4 v[104:107], v1, s[8:11], s48 offen offset:1024 sc1
  s_waitcnt vmcnt(14)
  v_mfma_f32_16x16x32_bf16 v[40:43], v[124:127], v[108:111], 0
  v_mfma_f32_16x16x32_bf16 v[40:43], v[128:131], v[112:115], v[40:43]
  v_mfma_f32_16x16x32_bf16 v[40:43], v[132:135], v[116:119], v[40:43]
  v_mfma_f32_16x16x32_bf16 v[40:43], v[136:139], v[120:123], v[40:43]
  s_waitcnt vmcnt(13)
  v_mfma_f32_16x16x32_bf16 v[32:35], v[144:147], v[52:55], 0
  v_mfma_f32_16x16x32_bf16 v[36:39], v[200:203], v[52:55], 0
  s_waitcnt vmcnt(12)
  v_mfma_f32_16x16x32_bf16 v[32:35], v[148:151], v[56:59], v[32:35]
  v_mfma_f32_16x16x32_bf16 v[36:39], v[204:207], v[56:59], v[36:39]
  s_waitcnt vmcnt(11)
  v_mfma_f32_16x16x32_bf16 v[32:35], v[152:155], v[60:63], v[32:35]
  v_mfma_f32_16x16x32_bf16 v[36:39], v[208:211], v[60:63], v[36:39]
  s_waitcnt vmcnt(10)
  v_mfma_f32_16x16x32_bf16 v[32:35], v[156:159], v[64:67], v[32:35]
  v_mfma_f32_16x16x32_bf16 v[36:39], v[212:215], v[64:67], v[36:39]
  s_waitcnt vmcnt(9)
  v_mfma_f32_16x16x32_bf16 v[32:35], v[160:163], v[68:71], v[32:35]
  v_mfma_f32_16x16x32_bf16 v[36:39], v[216:219], v[68:71], v[36:39]
  s_waitcnt vmcnt(8)
  v_mfma_f32_16x16x32_bf16 v[32:35], v[164:167], v[72:75], v[32:35]
  v_mfma_f32_16x16x32_bf16 v[36:39], v[220:223], v[72:75], v[36:39]
  s_waitcnt vmcnt(7)
  v_mfma_f32_16x16x32_bf16 v[32:35], v[168:171], v[76:79], v[32:35]
  v_mfma_f32_16x16x32_bf16 v[36:39], v[224:227], v[76:79], v[36:39]
  s_lshl_b32 s36, s26, 15
  s_add_u32 s36, s36, s60
  s_add_u32 s36, s36, 50331648
  s_mov_b32 exec_hi, 0
  buffer_load_dword v12, v15, s[8:11], s36 offen offset:1020 sc1
  s_waitcnt vmcnt(7)
  v_mfma_f32_16x16x32_bf16 v[32:35], v[172:175], v[80:83], v[32:35]
  v_mfma_f32_16x16x32_bf16 v[36:39], v[228:231], v[80:83], v[36:39]
  s_waitcnt vmcnt(6)
  v_mfma_f32_16x16x32_bf16 v[32:35], v[176:179], v[84:87], v[32:35]
  v_mfma_f32_16x16x32_bf16 v[36:39], v[232:235], v[84:87], v[36:39]
  s_waitcnt vmcnt(5)
  v_mfma_f32_16x16x32_bf16 v[32:35], v[180:183], v[88:91], v[32:35]
  v_mfma_f32_16x16x32_bf16 v[36:39], v[236:239], v[88:91], v[36:39]
  s_waitcnt vmcnt(4)
  v_mfma_f32_16x16x32_bf16 v[32:35], v[184:187], v[92:95], v[32:35]
  v_mfma_f32_16x16x32_bf16 v[36:39], v[240:243], v[92:95], v[36:39]
  s_waitcnt vmcnt(3)
  v_mfma_f32_16x16x32_bf16 v[32:35], v[188:191], v[96:99], v[32:35]
  v_mfma_f32_16x16x32_bf16 v[36:39], v[244:247], v[96:99], v[36:39]
  s_waitcnt vmcnt(2)
  v_mfma_f32_16x16x32_bf16 v[32:35], v[192:195], v[100:103], v[32:35]
  v_mfma_f32_16x16x32_bf16 v[36:39], v[248:251], v[100:103], v[36:39]
  s_waitcnt vmcnt(1)
  v_mfma_f32_16x16x32_bf16 v[32:35], v[196:199], v[104:107], v[32:35]
  v_mfma_f32_16x16x32_bf16 v[36:39], v[252:255], v[104:107], v[36:39]
  s_branch L_B_pc
L_B_h1:
L_B_pj:
  s_lshl_b32 s36, s26, 15
  s_add_u32 s36, s36, s60
  s_add_u32 s36, s36, 50331648
  s_mov_b32 exec_hi, 0
L_B_pr:
  s_sub_u32 s100, s100, 1
  s_cbranch_scc1 L_end
  buffer_load_dword v12, v15, s[8:11], s36 offen offset:1020 sc1
L_B_pc:
  s_waitcnt vmcnt(0)
  v_cmp_eq_u32 vcc, -1, v12
  s_cbranch_vccnz L_B_pr
  s_mov_b64 exec, -1
  v_mov_b32 v12, 0
  s_xor_b32 s36, s36, s54
  s_xor_b32 s37, s36, 0
  buffer_load_dwordx4 v[52:55], v1, s[8:11], s37 offen offset:0 sc1
  buffer_load_dwordx4 v[56:59], v1, s[8:11], s37 offen offset:1024 sc1
  buffer_load_dwordx4 v[60:63], v1, s[8:11], s37 offen offset:2048 sc1
  buffer_load_dwordx4 v[64:67], v1, s[8:11], s37 offen offset:3072 sc1
  s_xor_b32 s37, s36, 4096
  buffer_load_dwordx4 v[68:71], v1, s[8:11], s37 offen offset:0 sc1
  buffer_load_dwordx4 v[72:75], v1, s[8:11], s37 offen offset:1024 sc1
  buffer_load_dwordx4 v[76:79], v1, s[8:11], s37 offen offset:2048 sc1
  buffer_load_dwordx4 v[80:83], v1, s[8:11], s37 offen offset:3072 sc1
  s_waitcnt vmcnt(7)
  v_mfma_f32_16x16x32_bf16 v[44:47], a[0:3], v[52:55], 0
  v_max3_u32 v12, v52, v53, v12
  v_mfma_f32_16x16x32_bf16 v[48:51], a[128:131], v[52:55], 0
  v_max3_u32 v12, v54, v55, v12
  s_xor_b32 s37, s36, 8192
  buffer_load_dwordx4 v[52:55], v1, s[8:11], s37 offen offset:0 sc1
  s_waitcnt vmcnt(7)
  v_mfma_f32_16x16x32_bf16 v[44:47], a[4:7], v[56:59], v[44:47]
  v_max3_u32 v12, v56, v57, v12
  v_mfma_f32_16x16x32_bf16 v[48:51], a[132:135], v[56:59], v[48:51]
  v_max3_u32 v12, v58, v59, v12
  buffer_load_dwordx4 v[56:59], v1, s[8:11], s37 offen offset:1024 sc1
  s_waitcnt vmcnt(7)
  v_mfma_f32_16x16x32_bf16 v[44:47], a[8:11], v[60:63], v[44:47]
  v_max3_u32 v12, v60, v61, v12
  v_mfma_f32_16x16x32_bf16 v[48:51], a[136:139], v[60:63], v[48:51]
  v_max3_u32 v12, v62, v63, v12
  buffer_load_dwordx4 v[60:63], v1, s[8:11], s37 offen offset:2048 sc1
  s_waitcnt vmcnt(7)
  v_mfma_f32_16x16x32_bf16 v[44:47], a[12:15], v[64:67], v[44:47]
  v_max3_u32 v12, v64, v65, v12
  v_mfma_f32_16x16x32_bf16 v[48:51], a[140:143], v[64:67], v[48:51]
  v_max3_u32 v12, v66, v67, v12
  buffer_load_dwordx4 v[64:67], v1, s[8:11], s37 offen offset:3072 sc1
  s_waitcnt vmcnt(7)
  v_mfma_f32_16x16x32_bf16 v[44:47], a[16:19], v[68:71], v[44:47]
  v_max3_u32 v12, v68, v69, v12
  v_mfma_f32_16x16x32_bf16 v[48:51], a[144:147], v[68:71], v[48:51]
  v_max3_u32 v12, v70, v71, v12
  s_xor_b32 s37, s36, 12288
  buffer_load_dwordx4 v[68:71], v1, s[8:11], s37 offen offset:0 sc1
  s_waitcnt vmcnt(7)
  v_mfma_f32_16x16x32_bf16 v[44:47], a[20:23], v[72:75], v[44:47]
  v_max3_u32 v12, v72, v73, v12
  v_mfma_f32_16x16x32_bf16 v[48:51], a[148:151], v[72:75], v[48:51]
  v_max3_u32 v12, v74, v75, v12
  buffer_load_dwordx4 v[72:75], v1, s[8:11], s37 offen offset:1024 sc1
  s_waitcnt vmcnt(7)
  v_mfma_f32_16x16x32_bf16 v[44:47], a[24:27], v[76:79], v[44:47]
  v_max3_u32 v12, v76, v77, v12
  v_mfma_f32_16x16x32_bf16 v[48:51], a[152:155], v[76:79], v[48:51]
  v_max3_u32 v12, v78, v79, v12
  buffer_load_dwordx4 v[76:79], v1, s[8:11], s37 offen offset:2048 sc1
  s_waitcnt vmcnt(7)
  v_mfma_f32_16x16x32_bf16 v[44:47], a[28:31], v[80:83], v[44:47]
  v_max3_u32 v12, v80, v81, v12
  v_mfma_f32_16x16x32_bf16 v[48:51], a[156:159], v[80:83], v[48:51]
  v_max3_u32 v12, v82, v83, v12
  buffer_load_dwordx4 v[80:83], v1, s[8:11], s37 offen offset:3072 sc1
  s_waitcnt vmcnt(7)
  v_mfma_f32_16x16x32_bf16 v[44:47], a[32:35], v[52:55], v[44:47]
  v_max3_u32 v12, v52, v53, v12
  v_mfma_f32_16x16x32_bf16 v[48:51], a[160:163], v[52:55], v[48:51]
  v_max3_u32 v12, v54, v55, v12
  s_xor_b32 s37, s36, 16384
  buffer_load_dwordx4 v[52:55], v1, s[8:11], s37 offen offset:0 sc1
  s_waitcnt vmcnt(7)
  v_mfma_f32_16x16x32_bf16 v[44:47], a[36:39], v[56:59], v[44:47]
  v_max3_u32 v12, v56, v57, v12
  v_mfma_f32_16x16x32_bf16 v[48:51], a[164:167], v[56:59], v[48:51]
  v_max3_u32 v12, v58, v59, v12
  buffer_load_dwordx4 v[56:59], v1, s[8:11], s37 offen offset:1024 sc1
  s_waitcnt vmcnt(7)
  v_mfma_f32_16x16x32_bf16 v[44:47], a[40:43], v[60:63], v[44:47]
  v_max3_u32 v12, v60, v61, v12
  v_mfma_f32_16x16x32_bf16 v[48:51], a[168:171], v[60:63], v[48:51]
  v_max3_u32 v12, v62, v63, v12
  buffer_load_dwordx4 v[60:63], v1, s[8:11], s37 offen offset:2048 sc1
  s_waitcnt vmcnt(7)
  v_mfma_f32_16x16x32_bf16 v[44:47], a[44:47], v[64:67], v[44:47]
  v_max3_u32 v12, v64, v65, v12
  v_mfma_f32_16x16x32_bf16 v[48:51], a[172:175], v[64:67], v[48:51]
  v_max3_u32 v12, v66, v67, v12
  buffer_load_dwordx4 v[64:67], v1, s[8:11], s37 offen offset:3072 sc1
  s_waitcnt vmcnt(7)
  v_mfma_f32_16x16x32_bf16 v[44:47], a[48:51], v[68:71], v[44:47]
  v_max3_u32 v12, v68, v69, v12
  v_mfma_f32_16x16x32_bf16 v[48:51], a[176:179], v[68:71], v[48:51]
  v_max3_u32 v12, v70, v71, v12
  s_xor_b32 s37, s36, 20480
  buffer_load_dwordx4 v[68:71], v1, s[8:11], s37 offen offset:0 sc1
  s_waitcnt vmcnt(7)
  v_mfma_f32_16x16x32_bf16 v[44:47], a[52:55], v[72:75], v[44:47]
  v_max3_u32 v12, v72, v73, v12
  v_mfma_f32_16x16x32_bf16 v[48:51], a[180:183], v[72:75], v[48:51]
  v_max3_u32 v12, v74, v75, v12
  buffer_load_dwordx4 v[72:75], v1, s[8:11], s37 offen offset:1024 sc1
  s_waitcnt vmcnt(7)
  v_mfma_f32_16x16x32_bf16 v[44:47], a[56:59], v[76:79], v[44:47]
  v_max3_u32 v12, v76, v77, v12
  v_mfma_f32_16x16x32_bf16 v[48:51], a[184:187], v[76:79], v[48:51]
  v_max3_u32 v12, v78, v79, v12
  buffer_load_dwordx4 v[76:79], v1, s[8:11], s37 offen offset:2048 sc1
  s_waitcnt vmcnt(7)
  v_mfma_f32_16x16x32_bf16 v[44:47], a[60:63], v[80:83], v[44:47]
  v_max3_u32 v12, v80, v81, v12
  v_mfma_f32_16x16x32_bf16 v[48:51], a[188:191], v[80:83], v[48:51]
  v_max3_u32 v12, v82, v83, v12
  buffer_load_dwordx4 v[80:83], v1, s[8:11], s37 offen offset:3072 sc1
  s_waitcnt vmcnt(7)
  v_mfma_f32_16x16x32_bf16 v[44:47], a[64:67], v[52:55], v[44:47]
  v_max3_u32 v12, v52, v53, v12
  v_mfma_f32_16x16x32_bf16 v[48:51], a[192:195], v[52:55], v[48:51]
  v_max3_u32 v12, v54, v55, v12
  s_xor_b32 s37, s36, 24576
  buffer_load_dwordx4 v[52:55], v1, s[8:11], s37 offen offset:0 sc1
  s_waitcnt vmcnt(7)
  v_mfma_f32_16x16x32_bf16 v[44:47], a[68:71], v[56:59], v[44:47]
  v_max3_u32 v12, v56, v57, v12
  v_mfma_f32_16x16x32_bf16 v[48:51], a[196:199], v[56:59], v[48:51]
  v_max3_u32 v12, v58, v59, v12
  buffer_load_dwordx4 v[56:59], v1, s[8:11], s37 offen offset:1024 sc1
  s_waitcnt vmcnt(7)
  v_mfma_f32_16x16x32_bf16 v[44:47], a[72:75], v[60:63], v[44:47]
  v_max3_u32 v12, v60, v61, v12
  v_mfma_f32_16x16x32_bf16 v[48:51], a[200:203], v[60:63], v[48:51]
  v_max3_u32 v12, v62, v63, v12
  buffer_load_dwordx4 v[60:63], v1, s[8:11], s37 offen offset:2048 sc1
  s_waitcnt vmcnt(7)
  v_mfma_f32_16x16x32_bf16 v[44:47], a[76:79], v[64:67], v[44:47]
  v_max3_u32 v12, v64, v65, v12
  v_mfma_f32_16x16x32_bf16 v[48:51], a[204:207], v[64:67], v[48:51]
  v_max3_u32 v12, v66, v67, v12
  buffer_load_dwordx4 v[64:67], v1, s[8:11], s37 offen offset:3072 sc1
  s_waitcnt vmcnt(7)
  v_mfma_f32_16x16x32_bf16 v[44:47], a[80:83], v[68:71], v[44:47]
  v_max3_u32 v12, v68, v69, v12
  v_mfma_f32_16x16x32_bf16 v[48:51], a[208:211], v[68:71], v[48:51]
  v_max3_u32 v12, v70, v71, v12
  s_xor_b32 s37, s36, 28672
  buffer_load_dwordx4 v[68:71], v1, s[8:11], s37 offen offset:0 sc1
  s_waitcnt vmcnt(7)
  v_mfma_f32_16x16x32_bf16 v[44:47], a[84:87], v[72:75], v[44:47]
  v_max3_u32 v12, v72, v73, v12
  v_mfma_f32_16x16x32_bf16 v[48:51], a[212:215], v[72:75], v[48:51]
  v_max3_u32 v12, v74, v75, v12
  buffer_load_dwordx4 v[72:75], v1, s[8:11], s37 offen offset:1024 sc1
  s_waitcnt vmcnt(7)
  v_mfma_f32_16x16x32_bf16 v[44:47], a[88:91], v[76:79], v[44:47]
  v_max3_u32 v12, v76, v77, v12
  v_mfma_f32_16x16x32_bf16 v[48:51], a[216:219], v[76:79], v[48:51]
  v_max3_u32 v12, v78, v79, v12
  buffer_load_dwordx4 v[76:79], v1, s[8:11], s37 offen offset:2048 sc1
  s_waitcnt vmcnt(7)
  v_mfma_f32_16x16x32_bf16 v[44:47], a[92:95], v[80:83], v[44:47]
  v_max3_u32 v12, v80, v81, v12
  v_mfma_f32_16x16x32_bf16 v[48:51], a[220:223], v[80:83], v[48:51]
  v_max3_u32 v12, v82, v83, v12
  buffer_load_dwordx4 v[80:83], v1, s[8:11], s37 offen offset:3072 sc1
  s_waitcnt vmcnt(7)
  v_mfma_f32_16x16x32_bf16 v[44:47], a[96:99], v[52:55], v[44:47]
  v_max3_u32 v12, v52, v53, v12
  v_mfma_f32_16x16x32_bf16 v[48:51], a[224:227], v[52:55], v[48:51]
  v_max3_u32 v12, v54, v55, v12
  s_waitcnt vmcnt(6)
  v_mfma_f32_16x16x32_bf16 v[44:47], a[100:103], v[56:59], v[44:47]
  v_max3_u32 v12, v56, v57, v12
  v_mfma_f32_16x16x32_bf16 v[48:51], a[228:231], v[56:59], v[48:51]
  v_max3_u32 v12, v58, v59, v12
  s_waitcnt vmcnt(5)
  v_mfma_f32_16x16x32_bf16 v[44:47], a[104:107], v[60:63], v[44:47]
  v_max3_u32 v12, v60, v61, v12
  v_mfma_f32_16x16x32_bf16 v[48:51], a[232:235], v[60:63], v[48:51]
  v_max3_u32 v12, v62, v63, v12
  s_waitcnt vmcnt(4)
  v_mfma_f32_16x16x32_bf16 v[44:47], a[108:111], v[64:67], v[44:47]
  v_max3_u32 v12, v64, v65, v12
  v_mfma_f32_16x16x32_bf16 v[48:51], a[236:239], v[64:67], v[48:51]
  v_max3_u32 v12, v66, v67, v12
  s_waitcnt vmcnt(3)
  v_mfma_f32_16x16x32_bf16 v[44:47], a[112:115], v[68:71], v[44:47]
  v_max3_u32 v12, v68, v69, v12
  v_mfma_f32_16x16x32_bf16 v[48:51], a[240:243], v[68:71], v[48:51]
  v_max3_u32 v12, v70, v71, v12
  s_waitcnt vmcnt(2)
  v_mfma_f32_16x16x32_bf16 v[44:47], a[116:119], v[72:75], v[44:47]
  v_max3_u32 v12, v72, v73, v12
  v_mfma_f32_16x16x32_bf16 v[48:51], a[244:247], v[72:75], v[48:51]
  v_max3_u32 v12, v74, v75, v12
  s_waitcnt vmcnt(1)
  v_mfma_f32_16x16x32_bf16 v[44:47], a[120:123], v[76:79], v[44:47]
  v_max3_u32 v12, v76, v77, v12
  v_mfma_f32_16x16x32_bf16 v[48:51], a[248:251], v[76:79], v[48:51]
  v_max3_u32 v12, v78, v79, v12
  s_waitcnt vmcnt(0)
  v_mfma_f32_16x16x32_bf16 v[44:47], a[124:127], v[80:83], v[44:47]
  v_max3_u32 v12, v80, v81, v12
  v_mfma_f32_16x16x32_bf16 v[48:51], a[252:255], v[80:83], v[48:51]
  v_max3_u32 v12, v82, v83, v12
  v_cmp_eq_u32 vcc, -1, v12
  s_cbranch_vccnz L_B_pj
  s_lshl_b32 s36, s26, 10
  s_add_u32 s36, s36, s64
  v_add_u32 v12, s36, v1
  s_lshl_b32 s36, s26, 8
  s_add_u32 s36, s36, s64
  v_lshl_add_u32 v8, v0, 2, s36
  ds_write_b128 v12, v[32:35] offset:8192
  ds_write_b128 v12, v[36:39] offset:12288
  ds_write_b32 v8, v40 offset:16384
  ds_write_b128 v12, v[44:47]
  ds_write_b128 v12, v[48:51] offset:4096
  s_waitcnt lgkmcnt(0)
  s_barrier
  s_cmp_ge_u32 s26, 2
  s_cbranch_scc1 L_B_next
  s_lshl_b32 s36, s26, 12
  s_add_u32 s36, s36, s64
  v_add_u32 v12, s36, v1
  v_lshl_add_u32 v8, v0, 2, s64
  ds_read_b32 v84, v8 offset:16384
  ds_read_b32 v85, v8 offset:16640
  ds_read_b32 v86, v8 offset:16896
  ds_read_b32 v87, v8 offset:17152
  ds_read_b128 v[52:55], v12 offset:0
  ds_read_b128 v[56:59], v12 offset:1024
  ds_read_b128 v[60:63], v12 offset:2048
  ds_read_b128 v[64:67], v12 offset:3072
  ds_read_b128 v[68:71], v12 offset:8192
  ds_read_b128 v[72:75], v12 offset:9216
  ds_read_b128 v[76:79], v12 offset:10240
  ds_read_b128 v[80:83], v12 offset:11264
  s_waitcnt lgkmcnt(8)
  v_add_f32 v84, v84, v85
  v_add_f32 v86, v86, v87
  v_add_f32 v84, v84, v86
  v_cvt_pk_bf16_f32 v84, v84, v84
  v_and_b32 v84, 0xffff0000, v84
  v_mul_f32 v84, 0xbfb8aa3b, v84
  v_exp_f32 v84, v84
  s_nop 0
  v_add_f32 v84, 1.0, v84
  v_rcp_f32 v84, v84
  s_nop 0
  v_cvt_pk_bf16_f32 v84, v84, v84
  v_and_b32 v84, 0xffff0000, v84
  v_sub_f32 v85, 1.0, v84
  v_cvt_pk_bf16_f32 v85, v85, v85
  v_and_b32 v85, 0xffff0000, v85
  s_waitcnt lgkmcnt(0)
  v_add_f32 v52, v52, v56
  v_add_f32 v60, v60, v64
  v_add_f32 v53, v53, v57
  v_add_f32 v61, v61, v65
  v_add_f32 v54, v54, v58
  v_add_f32 v62, v62, v66
  v_add_f32 v55, v55, v59
  v_add_f32 v63, v63, v67
  v_add_f32 v52, v52, v60
  v_add_f32 v53, v53, v61
  v_add_f32 v54, v54, v62
  v_add_f32 v55, v55, v63
  v_cvt_pk_bf16_f32 v52, v52, v52
  v_and_b32 v52, 0xffff0000, v52
  v_cvt_pk_bf16_f32 v53, v53, v53
  v_and_b32 v53, 0xffff0000, v53
  v_cvt_pk_bf16_f32 v54, v54, v54
  v_and_b32 v54, 0xffff0000, v54
  v_cvt_pk_bf16_f32 v55, v55, v55
  v_and_b32 v55, 0xffff0000, v55
  v_mul_f32 v52, v52, v84
  v_mul_f32 v53, v53, v84
  v_mul_f32 v54, v54, v84
  v_mul_f32 v55, v55, v84
  v_cvt_pk_bf16_f32 v52, v52, v52
  v_and_b32 v52, 0xffff0000, v52
  v_cvt_pk_bf16_f32 v53, v53, v53
  v_and_b32 v53, 0xffff0000, v53
  v_cvt_pk_bf16_f32 v54, v54, v54
  v_and_b32 v54, 0xffff0000, v54
  v_cvt_pk_bf16_f32 v55, v55, v55
  v_and_b32 v55, 0xffff0000, v55
  v_add_f32 v68, v68, v72
  v_add_f32 v76, v76, v80
  v_add_f32 v69, v69, v73
  v_add_f32 v77, v77, v81
  v_add_f32 v70, v70, v74
  v_add_f32 v78, v78, v82
  v_add_f32 v71, v71, v75
  v_add_f32 v79, v79, v83
  v_add_f32 v68, v68, v76
  v_add_f32 v69, v69, v77
  v_add_f32 v70, v70, v78
  v_add_f32 v71, v71, v79
  v_cvt_pk_bf16_f32 v68, v68, v68
  v_and_b32 v68, 0xffff0000, v68
  v_cvt_pk_bf16_f32 v69, v69, v69
  v_and_b32 v69, 0xffff0000, v69
  v_cvt_pk_bf16_f32 v70, v70, v70
  v_and_b32 v70, 0xffff0000, v70
  v_cvt_pk_bf16_f32 v71, v71, v71
  v_and_b32 v71, 0xffff0000, v71
  v_mul_f32 v68, v68, v85
  v_mul_f32 v69, v69, v85
  v_mul_f32 v70, v70, v85
  v_mul_f32 v71, v71, v85
  v_cvt_pk_bf16_f32 v68, v68, v68
  v_and_b32 v68, 0xffff0000, v68
  v_cvt_pk_bf16_f32 v69, v69, v69
  v_and_b32 v69, 0xffff0000, v69
  v_cvt_pk_bf16_f32 v70, v70, v70
  v_and_b32 v70, 0xffff0000, v70
  v_cvt_pk_bf16_f32 v71, v71, v71
  v_and_b32 v71, 0xffff0000, v71
  v_add_f32 v52, v52, v68
  v_add_f32 v53, v53, v69
  v_add_f32 v54, v54, v70
  v_add_f32 v55, v55, v71
  v_cvt_pk_bf16_f32 v52, v52, v53
  v_cvt_pk_bf16_f32 v53, v54, v55
  buffer_store_dwordx2 v[52:53], v6, s[20:23], s65 offen
L_B_next:
  s_xor_b32 s64, s64, 0x8000
  s_add_u32 s41, s41, 1
  s_add_u32 s40, s40, 6
  s_cmp_lt_u32 s40, 64
  s_cbranch_scc1 L_B_loop
  s_branch L_end
L_team:
  v_and_b32 v120, 15, v0
  v_lshrrev_b32 v121, 4, v0
  v_lshlrev_b32 v2, 4, v0
  v_and_b32 v122, 1, v121
  v_lshlrev_b32 v117, 15, v122
  v_lshrrev_b32 v122, 1, v121
  v_lshl_add_u32 v117, v122, 12, v117
  v_lshl_add_u32 v117, v120, 4, v117
  s_lshl_b32 s36, s26, 8
  v_add_u32 v117, s36, v117
  s_lshl_b32 s36, s28, 17
  s_add_u32 s38, s86, s36
  s_addc_u32 s39, s87, 0
  s_mov_b32 s72, s38
  s_and_b32 s73, s39, 0xffff
  s_mov_b32 s74, 131072
  s_mov_b32 s75, 0x20000
  s_mov_b32 s49, 0
  buffer_load_dwordx4 v[128:131], v117, s[72:75], s49 offen offset:0
  buffer_load_dwordx4 v[132:135], v117, s[72:75], s49 offen offset:1024
  s_mov_b32 s49, 16384
  buffer_load_dwordx4 v[136:139], v117, s[72:75], s49 offen offset:0
  buffer_load_dwordx4 v[140:143], v117, s[72:75], s49 offen offset:1024
  s_mov_b32 s49, 0
  buffer_load_dwordx4 v[144:147], v117, s[72:75], s49 offen offset:2048
  buffer_load_dwordx4 v[148:151], v117, s[72:75], s49 offen offset:3072
  s_mov_b32 s49, 16384
  buffer_load_dwordx4 v[152:155], v117, s[72:75], s49 offen offset:2048
  buffer_load_dwordx4 v[156:159], v117, s[72:75], s49 offen offset:3072
  s_mov_b32 s49, 8192
  buffer_load_dwordx4 v[160:163], v117, s[72:75], s49 offen offset:0
  buffer_load_dwordx4 v[164:167], v117, s[72:75], s49 offen offset:1024
  s_mov_b32 s49, 24576
  buffer_load_dwordx4 v[168:171], v117, s[72:75], s49 offen offset:0
  buffer_load_dwordx4 v[172:175], v117, s[72:75], s49 offen offset:1024
  s_mov_b32 s49, 8192
  buffer_load_dwordx4 v[176:179], v117, s[72:75], s49 offen offset:2048
  buffer_load_dwordx4 v[180:183], v117, s[72:75], s49 offen offset:3072
  s_mov_b32 s49, 24576
  buffer_load_dwordx4 v[184:187], v117, s[72:75], s49 offen offset:2048
  buffer_load_dwordx4 v[188:191], v117, s[72:75], s49 offen offset:3072
  s_mov_b32 s49, 65536
  buffer_load_dwordx4 v[192:195], v117, s[72:75], s49 offen offset:0
  buffer_load_dwordx4 v[196:199], v117, s[72:75], s49 offen offset:1024
  s_mov_b32 s49, 81920
  buffer_load_dwordx4 v[200:203], v117, s[72:75], s49 offen offset:0
  buffer_load_dwordx4 v[204:207], v117, s[72:75], s49 offen offset:1024
  s_mov_b32 s49, 65536
  buffer_load_dwordx4 v[208:211], v117, s[72:75], s49 offen offset:2048
  buffer_load_dwordx4 v[212:215], v117, s[72:75], s49 offen offset:3072
  s_mov_b32 s49, 81920
  buffer_load_dwordx4 v[216:219], v117, s[72:75], s49 offen offset:2048
  buffer_load_dwordx4 v[220:223], v117, s[72:75], s49 offen offset:3072
  s_mov_b32 s49, 73728
  buffer_load_dwordx4 v[224:227], v117, s[72:75], s49 offen offset:0
  buffer_load_dwordx4 v[228:231], v117, s[72:75], s49 offen offset:1024
  s_mov_b32 s49, 90112
  buffer_load_dwordx4 v[232:235], v117, s[72:75], s49 offen offset:0
  buffer_load_dwordx4 v[236:239], v117, s[72:75], s49 offen offset:1024
  s_mov_b32 s49, 73728
  buffer_load_dwordx4 v[240:243], v117, s[72:75], s49 offen offset:2048
  buffer_load_dwordx4 v[244:247], v117, s[72:75], s49 offen offset:3072
  s_mov_b32 s49, 90112
  buffer_load_dwordx4 v[248:251], v117, s[72:75], s49 offen offset:2048
  buffer_load_dwordx4 v[252:255], v117, s[72:75], s49 offen offset:3072
  v_lshrrev_b32 v122, 3, v0
  v_lshlrev_b32 v118, 13, v122
  v_and_b32 v123, 7, v0
  v_lshl_add_u32 v118, v123, 4, v118
  v_xor_b32 v9, 32, v118
  v_xor_b32 v10, 64, v118
  v_xor_b32 v11, 96, v118
  s_lshl_b32 s36, s28, 8
  s_lshr_b32 s37, s26, 1
  s_lshl_b32 s37, s37, 7
  s_add_u32 s36, s36, s37
  s_sub_u32 s37, 4194304, s36
  s_add_u32 s38, s80, s36
  s_addc_u32 s39, s81, 0
  s_mov_b32 s12, s38
  s_and_b32 s13, s39, 0xffff
  s_mov_b32 s14, s37
  s_mov_b32 s15, 0x20000
  s_add_u32 s38, s82, s36
  s_addc_u32 s39, s83, 0
  s_mov_b32 s16, s38
  s_and_b32 s17, s39, 0xffff
  s_mov_b32 s18, s37
  s_mov_b32 s19, 0x20000
  s_add_u32 s38, s84, s36
  s_addc_u32 s39, s85, 0
  s_mov_b32 s20, s38
  s_and_b32 s21, s39, 0xffff
  s_mov_b32 s22, s37
  s_mov_b32 s23, 0x20000
  s_mov_b32 s76, s88
  s_and_b32 s77, s89, 0xffff
  s_mov_b32 s78, 8192
  s_mov_b32 s79, 0x20000
  s_xor_b32 s58, s26, 0
  s_lshl_b32 s58, s58, 20
  s_xor_b32 s59, s26, 2
  s_lshl_b32 s59, s59, 20
  s_mul_i32 s50, s26, 40960
  s_add_u32 s50, s50, 8192
  s_add_u32 m0, s50, 16384
  s_add_u32 s48, s59, 0
  buffer_load_dwordx4 v118, s[12:15], s48 offen nt lds
  s_add_u32 m0, s50, 17408
  s_add_u32 s48, s59, 65536
  buffer_load_dwordx4 v9, s[12:15], s48 offen nt lds
  s_add_u32 m0, s50, 18432
  s_add_u32 s48, s59, 131072
  buffer_load_dwordx4 v118, s[12:15], s48 offen nt lds
  s_add_u32 m0, s50, 19456
  s_add_u32 s48, s59, 196608
  buffer_load_dwordx4 v9, s[12:15], s48 offen nt lds
  s_add_u32 m0, s50, 20480
  s_add_u32 s48, s59, 262144
  buffer_load_dwordx4 v10, s[12:15], s48 offen nt lds
  s_add_u32 m0, s50, 21504
  s_add_u32 s48, s59, 327680
  buffer_load_dwordx4 v11, s[12:15], s48 offen nt lds
  s_add_u32 m0, s50, 22528
  s_add_u32 s48, s59, 393216
  buffer_load_dwordx4 v10, s[12:15], s48 offen nt lds
  s_add_u32 m0, s50, 23552
  s_add_u32 s48, s59, 458752
  buffer_load_dwordx4 v11, s[12:15], s48 offen nt lds
  s_add_u32 m0, s50, 24576
  s_add_u32 s48, s59, 524288
  buffer_load_dwordx4 v118, s[12:15], s48 offen nt lds
  s_add_u32 m0, s50, 25600
  s_add_u32 s48, s59, 589824
  buffer_load_dwordx4 v9, s[12:15], s48 offen nt lds
  s_add_u32 m0, s50, 26624
  s_add_u32 s48, s59, 655360
  buffer_load_dwordx4 v118, s[12:15], s48 offen nt lds
  s_add_u32 m0, s50, 27648
  s_add_u32 s48, s59, 720896
  buffer_load_dwordx4 v9, s[12:15], s48 offen nt lds
  s_add_u32 m0, s50, 28672
  s_add_u32 s48, s59, 786432
  buffer_load_dwordx4 v10, s[12:15], s48 offen nt lds
  s_add_u32 m0, s50, 29696
  s_add_u32 s48, s59, 851968
  buffer_load_dwordx4 v11, s[12:15], s48 offen nt lds
  s_add_u32 m0, s50, 30720
  s_add_u32 s48, s59, 917504
  buffer_load_dwordx4 v10, s[12:15], s48 offen nt lds
  s_add_u32 m0, s50, 31744
  s_add_u32 s48, s59, 983040
  buffer_load_dwordx4 v11, s[12:15], s48 offen nt lds
  v_add_u32 v15, s50, v2
  s_lshl_b32 s36, s26, 11
  v_add_u32 v3, s36, v2
  s_lshr_b32 s37, s28, 3
  s_lshl_b32 s37, s37, 11
  s_lshl_b32 s38, s26, 9
  s_add_u32 s37, s37, s38
  s_and_b32 s38, s28, 1
  s_lshl_b32 s38, s38, 8
  s_add_u32 s37, s37, s38
  s_and_b32 s38, s28, 6
  s_lshl_b32 s38, s38, 5
  s_add_u32 s37, s37, s38
  s_cmp_ge_u32 s26, 1
  s_cselect_b64 s[34:35], -1, 1
  v_and_b32 v122, 3, v0
  v_lshlrev_b32 v122, 2, v122
  v_lshl_add_u32 v13, v121, 4, v122
  v_add_u32 v13, s37, v13
  s_mov_b32 s68, 0xf000f
  s_mov_b32 s69, 0xf000f
  s_mov_b32 s62, 0x33333333
  s_mov_b32 s63, 0x33333333
  s_mov_b32 s64, 0xcccccccc
  s_mov_b32 s65, 0xcccccccc
  s_lshl_b32 s54, s28, 11
  s_mul_i32 s36, s26, 63488
  s_add_u32 s54, s54, s36
  s_add_u32 s54, s54, 83886080
  s_add_u32 s44, s54, 0x40000
  v_bfe_u32 v122, v0, 3, 1
  v_bfe_u32 v123, v0, 2, 1
  v_lshl_add_u32 v123, v122, 3, v123
  v_lshl_add_u32 v123, v121, 5, v123
  v_lshlrev_b32 v112, 7, v123
  v_bfe_u32 v122, v0, 3, 2
  s_and_b32 s36, s26, 1
  s_lshl_b32 s36, s36, 1
  v_xor_b32 v122, s36, v122
  v_lshl_add_u32 v112, v122, 5, v112
  v_and_b32 v122, 3, v0
  v_lshl_add_u32 v112, v122, 3, v112
  s_xor_b32 s36, s26, 1
  s_mul_i32 s36, s36, 40960
  s_add_u32 s36, s36, 8192
  v_add_u32 v114, s36, v112
  v_add_u32 v112, s50, v112
  v_xor_b32 v113, 32, v112
  v_xor_b32 v115, 32, v114
  v_xor_b32 v4, 2048, v3
  v_xor_b32 v5, 4096, v3
  v_xor_b32 v6, 6144, v3
  v_and_b32 v122, 2, v120
  v_cmp_eq_u32 vcc, 0, v122
  v_mov_b32 v122, 0x4444
  v_mov_b32 v123, 0xeeee
  v_cndmask_b32 v1, v123, v122, vcc
  v_lshrrev_b32 v119, 2, v120
  v_and_b32 v123, 1, v120
  v_lshl_add_u32 v119, v119, 1, v123
  s_lshl_b32 s36, s26, 10
  s_add_u32 s37, s36, 122880
  v_lshrrev_b32 v123, 2, v120
  v_xor_b32 v123, v123, v121
  v_lshlrev_b32 v123, 3, v123
  v_lshl_add_u32 v7, v120, 5, v123
  v_add_u32 v7, s37, v7
  v_xor_b32 v8, v0, v121
  v_lshlrev_b32 v8, 3, v8
  v_add_u32 v8, 122880, v8
  s_lshl_b32 s36, s26, 11
  s_lshl_b32 s37, s28, 14
  s_add_u32 s36, s36, s37
  s_add_u32 s36, s36, 8192
  v_lshlrev_b32 v14, 7, v120
  v_add_u32 v14, s36, v14
  s_lshl_b32 s37, s28, 8
  s_add_u32 s37, s37, 85983232
  v_lshl_add_u32 v122, v0, 3, s37
  v_cmp_eq_u32 s[70:71], 0, v121
  s_nop 1
  v_cndmask_b32 v14, v14, v122, s[70:71]
  s_lshr_b32 s37, s26, 1
  s_lshl_b32 s37, s37, 10
  s_and_b32 s38, s26, 1
  s_lshl_b32 s38, s38, 3
  s_add_u32 s37, s37, s38
  s_mov_b32 s56, s37
  s_lshl_b32 s37, s26, 14
  s_lshl_b32 s38, s28, 6
  s_add_u32 s37, s37, s38
  v_and_b32 v123, 7, v0
  v_lshlrev_b32 v123, 3, v123
  v_lshrrev_b32 v12, 3, v0
  v_lshl_add_u32 v12, v12, 11, v123
  v_add_u32 v12, s37, v12
  v_lshlrev_b32 v117, 10, v119
  v_and_b32 v123, 1, v121
  v_lshl_add_u32 v117, v123, 7, v117
  v_lshrrev_b32 v123, 1, v121
  v_lshl_add_u32 v117, v123, 2, v117
  v_and_b32 v123, 2, v120
  v_lshl_add_u32 v117, v123, 3, v117
  s_lshl_b32 s36, s26, 8
  v_add_u32 v117, s36, v117
  v_and_b32 v122, 1, v120
  v_lshlrev_b32 v122, 4, v122
  v_mov_b32 v123, 0x3f80
  v_lshlrev_b32 v119, v122, v123
  v_cndmask_b32 v119, 0, v119, vcc
  s_mov_b32 s47, 0xbe0293ee
  s_mov_b32 s66, 0x3e0293ee
  s_mov_b32 s67, 0x3e0293ee
  s_lshl_b32 s52, s28, 8
  s_add_u32 s52, s52, 85860352
  s_lshl_b32 s41, s28, 14
  s_lshl_b32 s42, s28, 12
  s_add_u32 s42, s42, 75497472
  s_lshl_b32 s36, s26, 10
  s_sub_u32 s42, s42, s36
  s_sub_u32 s42, s42, 131072
  s_mov_b32 s40, 0
  s_mov_b32 s33, 0
  s_mov_b32 s43, 83886080
  s_mov_b32 s53, 83951616
  s_mov_b32 s51, 84017152
  s_mov_b32 s57, 84082688
  s_mov_b32 s45, 84959232
  s_waitcnt vmcnt(16)
  buffer_load_dword a144, v117, s[76:79], 0 offen offset:0
  buffer_load_dword a145, v117, s[76:79], 0 offen offset:32
  buffer_load_dword a146, v117, s[76:79], 0 offen offset:64
  buffer_load_dword a147, v117, s[76:79], 0 offen offset:96
  buffer_load_dword a148, v117, s[76:79], 0 offen offset:8
  buffer_load_dword a149, v117, s[76:79], 0 offen offset:40
  buffer_load_dword a150, v117, s[76:79], 0 offen offset:72
  buffer_load_dword a151, v117, s[76:79], 0 offen offset:104
  s_add_u32 m0, s50, 0
  s_add_u32 s48, s59, 0
  buffer_load_dwordx4 v118, s[16:19], s48 offen nt lds
  s_add_u32 m0, s50, 1024
  s_add_u32 s48, s59, 65536
  buffer_load_dwordx4 v9, s[16:19], s48 offen nt lds
  s_add_u32 m0, s50, 2048
  s_add_u32 s48, s59, 131072
  buffer_load_dwordx4 v118, s[16:19], s48 offen nt lds
  s_add_u32 m0, s50, 3072
  s_add_u32 s48, s59, 196608
  buffer_load_dwordx4 v9, s[16:19], s48 offen nt lds
  s_add_u32 m0, s50, 4096
  s_add_u32 s48, s59, 262144
  buffer_load_dwordx4 v10, s[16:19], s48 offen nt lds
  s_add_u32 m0, s50, 5120
  s_add_u32 s48, s59, 327680
  buffer_load_dwordx4 v11, s[16:19], s48 offen nt lds
  s_add_u32 m0, s50, 6144
  s_add_u32 s48, s59, 393216
  buffer_load_dwordx4 v10, s[16:19], s48 offen nt lds
  s_add_u32 m0, s50, 7168
  s_add_u32 s48, s59, 458752
  buffer_load_dwordx4 v11, s[16:19], s48 offen nt lds
  s_add_u32 m0, s50, 8192
  s_add_u32 s48, s59, 524288
  buffer_load_dwordx4 v118, s[16:19], s48 offen nt lds
  s_add_u32 m0, s50, 9216
  s_add_u32 s48, s59, 589824
  buffer_load_dwordx4 v9, s[16:19], s48 offen nt lds
  s_add_u32 m0, s50, 10240
  s_add_u32 s48, s59, 655360
  buffer_load_dwordx4 v118, s[16:19], s48 offen nt lds
  s_add_u32 m0, s50, 11264
  s_add_u32 s48, s59, 720896
  buffer_load_dwordx4 v9, s[16:19], s48 offen nt lds
  s_add_u32 m0, s50, 12288
  s_add_u32 s48, s59, 786432
  buffer_load_dwordx4 v10, s[16:19], s48 offen nt lds
  s_add_u32 m0, s50, 13312
  s_add_u32 s48, s59, 851968
  buffer_load_dwordx4 v11, s[16:19], s48 offen nt lds
  s_add_u32 m0, s50, 14336
  s_add_u32 s48, s59, 917504
  buffer_load_dwordx4 v10, s[16:19], s48 offen nt lds
  s_add_u32 m0, s50, 15360
  s_add_u32 s48, s59, 983040
  buffer_load_dwordx4 v11, s[16:19], s48 offen nt lds
  s_mov_b32 s36, 0x05040100
  s_mov_b32 s37, 0x07060302
  v_perm_b32 v124, v132, v128, s36
  v_perm_b32 v125, v140, v136, s36
  v_perm_b32 v126, v148, v144, s36
  v_perm_b32 v127, v156, v152, s36
  v_accvgpr_write_b32 a0, v124
  v_accvgpr_write_b32 a1, v125
  v_accvgpr_write_b32 a2, v126
  v_accvgpr_write_b32 a3, v127
  v_perm_b32 v124, v132, v128, s37
  v_perm_b32 v125, v140, v136, s37
  v_perm_b32 v126, v148, v144, s37
  v_perm_b32 v127, v156, v152, s37
  v_accvgpr_write_b32 a128, v124
  v_accvgpr_write_b32 a129, v125
  v_accvgpr_write_b32 a130, v126
  v_accvgpr_write_b32 a131, v127
  v_perm_b32 v124, v133, v129, s36
  v_perm_b32 v125, v141, v137, s36
  v_perm_b32 v126, v149, v145, s36
  v_perm_b32 v127, v157, v153, s36
  v_accvgpr_write_b32 a8, v124
  v_accvgpr_write_b32 a9, v125
  v_accvgpr_write_b32 a10, v126
  v_accvgpr_write_b32 a11, v127
  v_perm_b32 v124, v133, v129, s37
  v_perm_b32 v125, v141, v137, s37
  v_perm_b32 v126, v149, v145, s37
  v_perm_b32 v127, v157, v153, s37
  v_accvgpr_write_b32 a136, v124
  v_accvgpr_write_b32 a137, v125
  v_accvgpr_write_b32 a138, v126
  v_accvgpr_write_b32 a139, v127
  v_perm_b32 v16, v134, v130, s36
  v_perm_b32 v17, v142, v138, s36
  v_perm_b32 v18, v150, v146, s36
  v_perm_b32 v19, v158, v154, s36
  v_perm_b32 v32, v134, v130, s37
  v_perm_b32 v33, v142, v138, s37
  v_perm_b32 v34, v150, v146, s37
  v_perm_b32 v35, v158, v154, s37
  v_perm_b32 v48, v135, v131, s36
  v_perm_b32 v49, v143, v139, s36
  v_perm_b32 v50, v151, v147, s36
  v_perm_b32 v51, v159, v155, s36
  v_perm_b32 v64, v135, v131, s37
  v_perm_b32 v65, v143, v139, s37
  v_perm_b32 v66, v151, v147, s37
  v_perm_b32 v67, v159, v155, s37
  v_perm_b32 v124, v164, v160, s36
  v_perm_b32 v125, v172, v168, s36
  v_perm_b32 v126, v180, v176, s36
  v_perm_b32 v127, v188, v184, s36
  v_accvgpr_write_b32 a4, v124
  v_accvgpr_write_b32 a5, v125
  v_accvgpr_write_b32 a6, v126
  v_accvgpr_write_b32 a7, v127
  v_perm_b32 v124, v164, v160, s37
  v_perm_b32 v125, v172, v168, s37
  v_perm_b32 v126, v180, v176, s37
  v_perm_b32 v127, v188, v184, s37
  v_accvgpr_write_b32 a132, v124
  v_accvgpr_write_b32 a133, v125
  v_accvgpr_write_b32 a134, v126
  v_accvgpr_write_b32 a135, v127
  v_perm_b32 v124, v165, v161, s36
  v_perm_b32 v125, v173, v169, s36
  v_perm_b32 v126, v181, v177, s36
  v_perm_b32 v127, v189, v185, s36
  v_accvgpr_write_b32 a12, v124
  v_accvgpr_write_b32 a13, v125
  v_accvgpr_write_b32 a14, v126
  v_accvgpr_write_b32 a15, v127
  v_perm_b32 v124, v165, v161, s37
  v_perm_b32 v125, v173, v169, s37
  v_perm_b32 v126, v181, v177, s37
  v_perm_b32 v127, v189, v185, s37
  v_accvgpr_write_b32 a140, v124
  v_accvgpr_write_b32 a141, v125
  v_accvgpr_write_b32 a142, v126
  v_accvgpr_write_b32 a143, v127
  v_perm_b32 v20, v166, v162, s36
  v_perm_b32 v21, v174, v170, s36
  v_perm_b32 v22, v182, v178, s36
  v_perm_b32 v23, v190, v186, s36
  v_perm_b32 v36, v166, v162, s37
  v_perm_b32 v37, v174, v170, s37
  v_perm_b32 v38, v182, v178, s37
  v_perm_b32 v39, v190, v186, s37
  v_perm_b32 v52, v167, v163, s36
  v_perm_b32 v53, v175, v171, s36
  v_perm_b32 v54, v183, v179, s36
  v_perm_b32 v55, v191, v187, s36
  v_perm_b32 v68, v167, v163, s37
  v_perm_b32 v69, v175, v171, s37
  v_perm_b32 v70, v183, v179, s37
  v_perm_b32 v71, v191, v187, s37
  v_perm_b32 v124, v196, v192, s36
  v_perm_b32 v125, v204, v200, s36
  v_perm_b32 v126, v212, v208, s36
  v_perm_b32 v127, v220, v216, s36
  v_accvgpr_write_b32 a64, v124
  v_accvgpr_write_b32 a65, v125
  v_accvgpr_write_b32 a66, v126
  v_accvgpr_write_b32 a67, v127
  v_perm_b32 v124, v196, v192, s37
  v_perm_b32 v125, v204, v200, s37
  v_perm_b32 v126, v212, v208, s37
  v_perm_b32 v127, v220, v216, s37
  v_accvgpr_write_b32 a192, v124
  v_accvgpr_write_b32 a193, v125
  v_accvgpr_write_b32 a194, v126
  v_accvgpr_write_b32 a195, v127
  v_perm_b32 v124, v197, v193, s36
  v_perm_b32 v125, v205, v201, s36
  v_perm_b32 v126, v213, v209, s36
  v_perm_b32 v127, v221, v217, s36
  v_accvgpr_write_b32 a72, v124
  v_accvgpr_write_b32 a73, v125
  v_accvgpr_write_b32 a74, v126
  v_accvgpr_write_b32 a75, v127
  v_perm_b32 v124, v197, v193, s37
  v_perm_b32 v125, v205, v201, s37
  v_perm_b32 v126, v213, v209, s37
  v_perm_b32 v127, v221, v217, s37
  v_accvgpr_write_b32 a200, v124
  v_accvgpr_write_b32 a201, v125
  v_accvgpr_write_b32 a202, v126
  v_accvgpr_write_b32 a203, v127
  v_perm_b32 v24, v198, v194, s36
  v_perm_b32 v25, v206, v202, s36
  v_perm_b32 v26, v214, v210, s36
  v_perm_b32 v27, v222, v218, s36
  v_perm_b32 v40, v198, v194, s37
  v_perm_b32 v41, v206, v202, s37
  v_perm_b32 v42, v214, v210, s37
  v_perm_b32 v43, v222, v218, s37
  v_perm_b32 v56, v199, v195, s36
  v_perm_b32 v57, v207, v203, s36
  v_perm_b32 v58, v215, v211, s36
  v_perm_b32 v59, v223, v219, s36
  v_perm_b32 v72, v199, v195, s37
  v_perm_b32 v73, v207, v203, s37
  v_perm_b32 v74, v215, v211, s37
  v_perm_b32 v75, v223, v219, s37
  v_perm_b32 v124, v228, v224, s36
  v_perm_b32 v125, v236, v232, s36
  v_perm_b32 v126, v244, v240, s36
  v_perm_b32 v127, v252, v248, s36
  v_accvgpr_write_b32 a68, v124
  v_accvgpr_write_b32 a69, v125
  v_accvgpr_write_b32 a70, v126
  v_accvgpr_write_b32 a71, v127
  v_perm_b32 v124, v228, v224, s37
  v_perm_b32 v125, v236, v232, s37
  v_perm_b32 v126, v244, v240, s37
  v_perm_b32 v127, v252, v248, s37
  v_accvgpr_write_b32 a196, v124
  v_accvgpr_write_b32 a197, v125
  v_accvgpr_write_b32 a198, v126
  v_accvgpr_write_b32 a199, v127
  v_perm_b32 v124, v229, v225, s36
  v_perm_b32 v125, v237, v233, s36
  v_perm_b32 v126, v245, v241, s36
  v_perm_b32 v127, v253, v249, s36
  v_accvgpr_write_b32 a76, v124
  v_accvgpr_write_b32 a77, v125
  v_accvgpr_write_b32 a78, v126
  v_accvgpr_write_b32 a79, v127
  v_perm_b32 v124, v229, v225, s37
  v_perm_b32 v125, v237, v233, s37
  v_perm_b32 v126, v245, v241, s37
  v_perm_b32 v127, v253, v249, s37
  v_accvgpr_write_b32 a204, v124
  v_accvgpr_write_b32 a205, v125
  v_accvgpr_write_b32 a206, v126
  v_accvgpr_write_b32 a207, v127
  v_perm_b32 v28, v230, v226, s36
  v_perm_b32 v29, v238, v234, s36
  v_perm_b32 v30, v246, v242, s36
  v_perm_b32 v31, v254, v250, s36
  v_perm_b32 v44, v230, v226, s37
  v_perm_b32 v45, v238, v234, s37
  v_perm_b32 v46, v246, v242, s37
  v_perm_b32 v47, v254, v250, s37
  v_perm_b32 v60, v231, v227, s36
  v_perm_b32 v61, v239, v235, s36
  v_perm_b32 v62, v247, v243, s36
  v_perm_b32 v63, v255, v251, s36
  v_perm_b32 v76, v231, v227, s37
  v_perm_b32 v77, v239, v235, s37
  v_perm_b32 v78, v247, v243, s37
  v_perm_b32 v79, v255, v251, s37
  s_waitcnt vmcnt(16)
  s_barrier
  ds_read_b64_tr_b16 a[32:33], v112 offset:16384
  ds_read_b64_tr_b16 a[34:35], v112 offset:18432
  ds_read_b64_tr_b16 a[96:97], v113 offset:16384
  ds_read_b64_tr_b16 a[98:99], v113 offset:18432
  ds_read_b64_tr_b16 a[36:37], v112 offset:16640
  ds_read_b64_tr_b16 a[38:39], v112 offset:18688
  ds_read_b64_tr_b16 a[100:101], v113 offset:16640
  ds_read_b64_tr_b16 a[102:103], v113 offset:18688
  ds_read_b64_tr_b16 a[40:41], v112 offset:16896
  ds_read_b64_tr_b16 a[42:43], v112 offset:18944
  ds_read_b64_tr_b16 a[104:105], v113 offset:16896
  ds_read_b64_tr_b16 a[106:107], v113 offset:18944
  ds_read_b64_tr_b16 a[44:45], v112 offset:17152
  ds_read_b64_tr_b16 a[46:47], v112 offset:19200
  ds_read_b64_tr_b16 a[108:109], v113 offset:17152
  ds_read_b64_tr_b16 a[110:111], v113 offset:19200
  ds_read_b64_tr_b16 a[48:49], v114 offset:16384
  ds_read_b64_tr_b16 a[50:51], v114 offset:18432
  ds_read_b64_tr_b16 a[112:113], v115 offset:16384
  ds_read_b64_tr_b16 a[114:115], v115 offset:18432
  ds_read_b64_tr_b16 a[52:53], v114 offset:16640
  ds_read_b64_tr_b16 a[54:55], v114 offset:18688
  ds_read_b64_tr_b16 a[116:117], v115 offset:16640
  ds_read_b64_tr_b16 a[118:119], v115 offset:18688
  ds_read_b64_tr_b16 a[56:57], v114 offset:16896
  ds_read_b64_tr_b16 a[58:59], v114 offset:18944
  ds_read_b64_tr_b16 a[120:121], v115 offset:16896
  ds_read_b64_tr_b16 a[122:123], v115 offset:18944
  ds_read_b64_tr_b16 a[60:61], v114 offset:17152
  ds_read_b64_tr_b16 a[62:63], v114 offset:19200
  ds_read_b64_tr_b16 a[124:125], v115 offset:17152
  ds_read_b64_tr_b16 a[126:127], v115 offset:19200
  s_waitcnt lgkmcnt(0)
  s_barrier
  s_add_u32 m0, s50, 16384
  s_add_u32 s48, s58, 0
  buffer_load_dwordx4 v118, s[20:23], s48 offen nt lds
  s_add_u32 m0, s50, 17408
  s_add_u32 s48, s58, 65536
  buffer_load_dwordx4 v9, s[20:23], s48 offen nt lds
  s_add_u32 m0, s50, 18432
  s_add_u32 s48, s58, 131072
  buffer_load_dwordx4 v118, s[20:23], s48 offen nt lds
  s_add_u32 m0, s50, 19456
  s_add_u32 s48, s58, 196608
  buffer_load_dwordx4 v9, s[20:23], s48 offen nt lds
  s_add_u32 m0, s50, 20480
  s_add_u32 s48, s58, 262144
  buffer_load_dwordx4 v10, s[20:23], s48 offen nt lds
  s_add_u32 m0, s50, 21504
  s_add_u32 s48, s58, 327680
  buffer_load_dwordx4 v11, s[20:23], s48 offen nt lds
  s_add_u32 m0, s50, 22528
  s_add_u32 s48, s58, 393216
  buffer_load_dwordx4 v10, s[20:23], s48 offen nt lds
  s_add_u32 m0, s50, 23552
  s_add_u32 s48, s58, 458752
  buffer_load_dwordx4 v11, s[20:23], s48 offen nt lds
  s_add_u32 m0, s50, 24576
  s_add_u32 s48, s58, 524288
  buffer_load_dwordx4 v118, s[20:23], s48 offen nt lds
  s_add_u32 m0, s50, 25600
  s_add_u32 s48, s58, 589824
  buffer_load_dwordx4 v9, s[20:23], s48 offen nt lds
  s_add_u32 m0, s50, 26624
  s_add_u32 s48, s58, 655360
  buffer_load_dwordx4 v118, s[20:23], s48 offen nt lds
  s_add_u32 m0, s50, 27648
  s_add_u32 s48, s58, 720896
  buffer_load_dwordx4 v9, s[20:23], s48 offen nt lds
  s_add_u32 m0, s50, 28672
  s_add_u32 s48, s58, 786432
  buffer_load_dwordx4 v10, s[20:23], s48 offen nt lds
  s_add_u32 m0, s50, 29696
  s_add_u32 s48, s58, 851968
  buffer_load_dwordx4 v11, s[20:23], s48 offen nt lds
  s_add_u32 m0, s50, 30720
  s_add_u32 s48, s58, 917504
  buffer_load_dwordx4 v10, s[20:23], s48 offen nt lds
  s_add_u32 m0, s50, 31744
  s_add_u32 s48, s58, 983040
  buffer_load_dwordx4 v11, s[20:23], s48 offen nt lds
  s_waitcnt vmcnt(16)
  s_barrier
  ds_read_b64_tr_b16 a[160:161], v112 offset:0
  ds_read_b64_tr_b16 a[162:163], v112 offset:2048
  ds_read_b64_tr_b16 a[224:225], v113 offset:0
  ds_read_b64_tr_b16 a[226:227], v113 offset:2048
  ds_read_b64_tr_b16 a[164:165], v112 offset:256
  ds_read_b64_tr_b16 a[166:167], v112 offset:2304
  ds_read_b64_tr_b16 a[228:229], v113 offset:256
  ds_read_b64_tr_b16 a[230:231], v113 offset:2304
  ds_read_b64_tr_b16 a[168:169], v112 offset:512
  ds_read_b64_tr_b16 a[170:171], v112 offset:2560
  ds_read_b64_tr_b16 a[232:233], v113 offset:512
  ds_read_b64_tr_b16 a[234:235], v113 offset:2560
  ds_read_b64_tr_b16 a[172:173], v112 offset:768
  ds_read_b64_tr_b16 a[174:175], v112 offset:2816
  ds_read_b64_tr_b16 a[236:237], v113 offset:768
  ds_read_b64_tr_b16 a[238:239], v113 offset:2816
  ds_read_b64_tr_b16 a[176:177], v114 offset:0
  ds_read_b64_tr_b16 a[178:179], v114 offset:2048
  ds_read_b64_tr_b16 a[240:241], v115 offset:0
  ds_read_b64_tr_b16 a[242:243], v115 offset:2048
  ds_read_b64_tr_b16 a[180:181], v114 offset:256
  ds_read_b64_tr_b16 a[182:183], v114 offset:2304
  ds_read_b64_tr_b16 a[244:245], v115 offset:256
  ds_read_b64_tr_b16 a[246:247], v115 offset:2304
  ds_read_b64_tr_b16 a[184:185], v114 offset:512
  ds_read_b64_tr_b16 a[186:187], v114 offset:2560
  ds_read_b64_tr_b16 a[248:249], v115 offset:512
  ds_read_b64_tr_b16 a[250:251], v115 offset:2560
  ds_read_b64_tr_b16 a[188:189], v114 offset:768
  ds_read_b64_tr_b16 a[190:191], v114 offset:2816
  ds_read_b64_tr_b16 a[252:253], v115 offset:768
  ds_read_b64_tr_b16 a[254:255], v115 offset:2816
  s_waitcnt lgkmcnt(0)
  s_barrier
  s_add_u32 m0, s50, 0
  s_add_u32 s48, s59, 0
  buffer_load_dwordx4 v118, s[20:23], s48 offen nt lds
  s_add_u32 m0, s50, 1024
  s_add_u32 s48, s59, 65536
  buffer_load_dwordx4 v9, s[20:23], s48 offen nt lds
  s_add_u32 m0, s50, 2048
  s_add_u32 s48, s59, 131072
  buffer_load_dwordx4 v118, s[20:23], s48 offen nt lds
  s_add_u32 m0, s50, 3072
  s_add_u32 s48, s59, 196608
  buffer_load_dwordx4 v9, s[20:23], s48 offen nt lds
  s_add_u32 m0, s50, 4096
  s_add_u32 s48, s59, 262144
  buffer_load_dwordx4 v10, s[20:23], s48 offen nt lds
  s_add_u32 m0, s50, 5120
  s_add_u32 s48, s59, 327680
  buffer_load_dwordx4 v11, s[20:23], s48 offen nt lds
  s_add_u32 m0, s50, 6144
  s_add_u32 s48, s59, 393216
  buffer_load_dwordx4 v10, s[20:23], s48 offen nt lds
  s_add_u32 m0, s50, 7168
  s_add_u32 s48, s59, 458752
  buffer_load_dwordx4 v11, s[20:23], s48 offen nt lds
  s_add_u32 m0, s50, 8192
  s_add_u32 s48, s59, 524288
  buffer_load_dwordx4 v118, s[20:23], s48 offen nt lds
  s_add_u32 m0, s50, 9216
  s_add_u32 s48, s59, 589824
  buffer_load_dwordx4 v9, s[20:23], s48 offen nt lds
  s_add_u32 m0, s50, 10240
  s_add_u32 s48, s59, 655360
  buffer_load_dwordx4 v118, s[20:23], s48 offen nt lds
  s_add_u32 m0, s50, 11264
  s_add_u32 s48, s59, 720896
  buffer_load_dwordx4 v9, s[20:23], s48 offen nt lds
  s_add_u32 m0, s50, 12288
  s_add_u32 s48, s59, 786432
  buffer_load_dwordx4 v10, s[20:23], s48 offen nt lds
  s_add_u32 m0, s50, 13312
  s_add_u32 s48, s59, 851968
  buffer_load_dwordx4 v11, s[20:23], s48 offen nt lds
  s_add_u32 m0, s50, 14336
  s_add_u32 s48, s59, 917504
  buffer_load_dwordx4 v10, s[20:23], s48 offen nt lds
  s_add_u32 m0, s50, 15360
  s_add_u32 s48, s59, 983040
  buffer_load_dwordx4 v11, s[20:23], s48 offen nt lds
  s_waitcnt vmcnt(16)
  s_barrier
  ds_read_b64_tr_b16 v[128:129], v112 offset:16384
  ds_read_b64_tr_b16 v[130:131], v112 offset:18432
  ds_read_b64_tr_b16 v[192:193], v113 offset:16384
  ds_read_b64_tr_b16 v[194:195], v113 offset:18432
  ds_read_b64_tr_b16 v[132:133], v112 offset:16640
  ds_read_b64_tr_b16 v[134:135], v112 offset:18688
  ds_read_b64_tr_b16 v[196:197], v113 offset:16640
  ds_read_b64_tr_b16 v[198:199], v113 offset:18688
  ds_read_b64_tr_b16 v[136:137], v112 offset:16896
  ds_read_b64_tr_b16 v[138:139], v112 offset:18944
  ds_read_b64_tr_b16 v[200:201], v113 offset:16896
  ds_read_b64_tr_b16 v[202:203], v113 offset:18944
  ds_read_b64_tr_b16 v[140:141], v112 offset:17152
  ds_read_b64_tr_b16 v[142:143], v112 offset:19200
  ds_read_b64_tr_b16 v[204:205], v113 offset:17152
  ds_read_b64_tr_b16 v[206:207], v113 offset:19200
  ds_read_b64_tr_b16 v[144:145], v114 offset:16384
  ds_read_b64_tr_b16 v[146:147], v114 offset:18432
  ds_read_b64_tr_b16 v[208:209], v115 offset:16384
  ds_read_b64_tr_b16 v[210:211], v115 offset:18432
  ds_read_b64_tr_b16 v[148:149], v114 offset:16640
  ds_read_b64_tr_b16 v[150:151], v114 offset:18688
  ds_read_b64_tr_b16 v[212:213], v115 offset:16640
  ds_read_b64_tr_b16 v[214:215], v115 offset:18688
  ds_read_b64_tr_b16 v[152:153], v114 offset:16896
  ds_read_b64_tr_b16 v[154:155], v114 offset:18944
  ds_read_b64_tr_b16 v[216:217], v115 offset:16896
  ds_read_b64_tr_b16 v[218:219], v115 offset:18944
  ds_read_b64_tr_b16 v[156:157], v114 offset:17152
  ds_read_b64_tr_b16 v[158:159], v114 offset:19200
  ds_read_b64_tr_b16 v[220:221], v115 offset:17152
  ds_read_b64_tr_b16 v[222:223], v115 offset:19200
  s_waitcnt lgkmcnt(0)
  s_barrier
  v_mov_b32 v122, 208
  global_load_dwordx2 v[124:125], v122, s[24:25] sc1
  global_load_dwordx2 v[120:121], v122, s[24:25] offset:-16 sc1
  s_add_u32 m0, s50, 16384
  s_add_u32 s48, s58, 0
  buffer_load_dwordx4 v118, s[12:15], s48 offen nt lds
  s_add_u32 m0, s50, 17408
  s_add_u32 s48, s58, 65536
  buffer_load_dwordx4 v9, s[12:15], s48 offen nt lds
  s_add_u32 m0, s50, 18432
  s_add_u32 s48, s58, 131072
  buffer_load_dwordx4 v118, s[12:15], s48 offen nt lds
  s_add_u32 m0, s50, 19456
  s_add_u32 s48, s58, 196608
  buffer_load_dwordx4 v9, s[12:15], s48 offen nt lds
  s_add_u32 m0, s50, 20480
  s_add_u32 s48, s58, 262144
  buffer_load_dwordx4 v10, s[12:15], s48 offen nt lds
  s_add_u32 m0, s50, 21504
  s_add_u32 s48, s58, 327680
  buffer_load_dwordx4 v11, s[12:15], s48 offen nt lds
  s_add_u32 m0, s50, 22528
  s_add_u32 s48, s58, 393216
  buffer_load_dwordx4 v10, s[12:15], s48 offen nt lds
  s_add_u32 m0, s50, 23552
  s_add_u32 s48, s58, 458752
  buffer_load_dwordx4 v11, s[12:15], s48 offen nt lds
  s_add_u32 m0, s50, 24576
  s_add_u32 s48, s58, 524288
  buffer_load_dwordx4 v118, s[12:15], s48 offen nt lds
  s_add_u32 m0, s50, 25600
  s_add_u32 s48, s58, 589824
  buffer_load_dwordx4 v9, s[12:15], s48 offen nt lds
  s_add_u32 m0, s50, 26624
  s_add_u32 s48, s58, 655360
  buffer_load_dwordx4 v118, s[12:15], s48 offen nt lds
  s_add_u32 m0, s50, 27648
  s_add_u32 s48, s58, 720896
  buffer_load_dwordx4 v9, s[12:15], s48 offen nt lds
  s_add_u32 m0, s50, 28672
  s_add_u32 s48, s58, 786432
  buffer_load_dwordx4 v10, s[12:15], s48 offen nt lds
  s_add_u32 m0, s50, 29696
  s_add_u32 s48, s58, 851968
  buffer_load_dwordx4 v11, s[12:15], s48 offen nt lds
  s_add_u32 m0, s50, 30720
  s_add_u32 s48, s58, 917504
  buffer_load_dwordx4 v10, s[12:15], s48 offen nt lds
  s_add_u32 m0, s50, 31744
  s_add_u32 s48, s58, 983040
  buffer_load_dwordx4 v11, s[12:15], s48 offen nt lds
  s_waitcnt vmcnt(16)
  s_barrier
  ds_read_b64_tr_b16 v[160:161], v112 offset:0
  ds_read_b64_tr_b16 v[162:163], v112 offset:2048
  ds_read_b64_tr_b16 v[224:225], v113 offset:0
  ds_read_b64_tr_b16 v[226:227], v113 offset:2048
  ds_read_b64_tr_b16 v[164:165], v112 offset:256
  ds_read_b64_tr_b16 v[166:167], v112 offset:2304
  ds_read_b64_tr_b16 v[228:229], v113 offset:256
  ds_read_b64_tr_b16 v[230:231], v113 offset:2304
  ds_read_b64_tr_b16 v[168:169], v112 offset:512
  ds_read_b64_tr_b16 v[170:171], v112 offset:2560
  ds_read_b64_tr_b16 v[232:233], v113 offset:512
  ds_read_b64_tr_b16 v[234:235], v113 offset:2560
  ds_read_b64_tr_b16 v[172:173], v112 offset:768
  ds_read_b64_tr_b16 v[174:175], v112 offset:2816
  ds_read_b64_tr_b16 v[236:237], v113 offset:768
  ds_read_b64_tr_b16 v[238:239], v113 offset:2816
  ds_read_b64_tr_b16 v[176:177], v114 offset:0
  ds_read_b64_tr_b16 v[178:179], v114 offset:2048
  ds_read_b64_tr_b16 v[240:241], v115 offset:0
  ds_read_b64_tr_b16 v[242:243], v115 offset:2048
  ds_read_b64_tr_b16 v[180:181], v114 offset:256
  ds_read_b64_tr_b16 v[182:183], v114 offset:2304
  ds_read_b64_tr_b16 v[244:245], v115 offset:256
  ds_read_b64_tr_b16 v[246:247], v115 offset:2304
  ds_read_b64_tr_b16 v[184:185], v114 offset:512
  ds_read_b64_tr_b16 v[186:187], v114 offset:2560
  ds_read_b64_tr_b16 v[248:249], v115 offset:512
  ds_read_b64_tr_b16 v[250:251], v115 offset:2560
  ds_read_b64_tr_b16 v[188:189], v114 offset:768
  ds_read_b64_tr_b16 v[190:191], v114 offset:2816
  ds_read_b64_tr_b16 v[252:253], v115 offset:768
  ds_read_b64_tr_b16 v[254:255], v115 offset:2816
  s_waitcnt lgkmcnt(0)
  s_barrier
  v_and_b32 v123, 0x3ff, v3
  v_lshlrev_b32 v123, 3, v123
  s_lshl_b32 s36, s26, 11
  v_add_u32 v123, s36, v123
  s_mov_b64 exec, 0xffff
  v_readfirstlane_b32 s97, v121
  s_nop 0
  s_cmp_lt_u32 s97, 16
  s_cbranch_scc1 L_T_nt
  s_mov_b32 s36, 84934656
  buffer_load_dword v116, v123, s[8:11], s36 offen sc1
  s_mov_b32 s36, 84942848
  buffer_load_dword v116, v123, s[8:11], s36 offen sc1
  s_mov_b32 s36, 84951040
  buffer_load_dword v116, v123, s[8:11], s36 offen sc1
  s_mov_b32 s36, 84959232
  buffer_load_dword v116, v123, s[8:11], s36 offen sc1
  buffer_load_dword v116, v123, s[8:11], s54 offen sc1
  buffer_load_dword v116, v123, s[8:11], s44 offen sc1
L_T_nt:
  s_mov_b64 exec, -1
  s_add_u32 m0, s50, 0
  s_add_u32 s48, s58, 0
  buffer_load_dwordx4 v118, s[16:19], s48 offen nt lds
  s_add_u32 m0, s50, 1024
  s_add_u32 s48, s58, 65536
  buffer_load_dwordx4 v9, s[16:19], s48 offen nt lds
  s_add_u32 m0, s50, 2048
  s_add_u32 s48, s58, 131072
  buffer_load_dwordx4 v118, s[16:19], s48 offen nt lds
  s_add_u32 m0, s50, 3072
  s_add_u32 s48, s58, 196608
  buffer_load_dwordx4 v9, s[16:19], s48 offen nt lds
  s_add_u32 m0, s50, 4096
  s_add_u32 s48, s58, 262144
  buffer_load_dwordx4 v10, s[16:19], s48 offen nt lds
  s_add_u32 m0, s50, 5120
  s_add_u32 s48, s58, 327680
  buffer_load_dwordx4 v11, s[16:19], s48 offen nt lds
  s_add_u32 m0, s50, 6144
  s_add_u32 s48, s58, 393216
  buffer_load_dwordx4 v10, s[16:19], s48 offen nt lds
  s_add_u32 m0, s50, 7168
  s_add_u32 s48, s58, 458752
  buffer_load_dwordx4 v11, s[16:19], s48 offen nt lds
  s_add_u32 m0, s50, 8192
  s_add_u32 s48, s58, 524288
  buffer_load_dwordx4 v118, s[16:19], s48 offen nt lds
  s_add_u32 m0, s50, 9216
  s_add_u32 s48, s58, 589824
  buffer_load_dwordx4 v9, s[16:19], s48 offen nt lds
  s_add_u32 m0, s50, 10240
  s_add_u32 s48, s58, 655360
  buffer_load_dwordx4 v118, s[16:19], s48 offen nt lds
  s_add_u32 m0, s50, 11264
  s_add_u32 s48, s58, 720896
  buffer_load_dwordx4 v9, s[16:19], s48 offen nt lds
  s_add_u32 m0, s50, 12288
  s_add_u32 s48, s58, 786432
  buffer_load_dwordx4 v10, s[16:19], s48 offen nt lds
  s_add_u32 m0, s50, 13312
  s_add_u32 s48, s58, 851968
  buffer_load_dwordx4 v11, s[16:19], s48 offen nt lds
  s_add_u32 m0, s50, 14336
  s_add_u32 s48, s58, 917504
  buffer_load_dwordx4 v10, s[16:19], s48 offen nt lds
  s_add_u32 m0, s50, 15360
  s_add_u32 s48, s58, 983040
  buffer_load_dwordx4 v11, s[16:19], s48 offen nt lds
  s_waitcnt vmcnt(16)
  s_barrier
  ds_read_b64_tr_b16 v[80:81], v112 offset:16384
  ds_read_b64_tr_b16 v[82:83], v112 offset:18432
  ds_read_b64_tr_b16 v[96:97], v113 offset:16384
  ds_read_b64_tr_b16 v[98:99], v113 offset:18432
  ds_read_b64_tr_b16 v[84:85], v112 offset:16640
  ds_read_b64_tr_b16 v[86:87], v112 offset:18688
  ds_read_b64_tr_b16 v[100:101], v113 offset:16640
  ds_read_b64_tr_b16 v[102:103], v113 offset:18688
  ds_read_b64_tr_b16 v[88:89], v112 offset:16896
  ds_read_b64_tr_b16 v[90:91], v112 offset:18944
  ds_read_b64_tr_b16 v[104:105], v113 offset:16896
  ds_read_b64_tr_b16 v[106:107], v113 offset:18944
  ds_read_b64_tr_b16 v[92:93], v112 offset:17152
  ds_read_b64_tr_b16 v[94:95], v112 offset:19200
  ds_read_b64_tr_b16 v[108:109], v113 offset:17152
  ds_read_b64_tr_b16 v[110:111], v113 offset:19200
  ds_read_b64_tr_b16 a[16:17], v114 offset:16384
  ds_read_b64_tr_b16 a[18:19], v114 offset:18432
  ds_read_b64_tr_b16 a[80:81], v115 offset:16384
  ds_read_b64_tr_b16 a[82:83], v115 offset:18432
  ds_read_b64_tr_b16 a[20:21], v114 offset:16640
  ds_read_b64_tr_b16 a[22:23], v114 offset:18688
  ds_read_b64_tr_b16 a[84:85], v115 offset:16640
  ds_read_b64_tr_b16 a[86:87], v115 offset:18688
  ds_read_b64_tr_b16 a[24:25], v114 offset:16896
  ds_read_b64_tr_b16 a[26:27], v114 offset:18944
  ds_read_b64_tr_b16 a[88:89], v115 offset:16896
  ds_read_b64_tr_b16 a[90:91], v115 offset:18944
  ds_read_b64_tr_b16 a[28:29], v114 offset:17152
  ds_read_b64_tr_b16 a[30:31], v114 offset:19200
  ds_read_b64_tr_b16 a[92:93], v115 offset:17152
  ds_read_b64_tr_b16 a[94:95], v115 offset:19200
  s_waitcnt lgkmcnt(0)
  s_barrier
  ds_write_b128 v15, v[16:19] offset:16384
  ds_write_b128 v15, v[20:23] offset:17408
  ds_write_b128 v15, v[24:27] offset:18432
  ds_write_b128 v15, v[28:31] offset:19456
  ds_write_b128 v15, v[32:35] offset:20480
  ds_write_b128 v15, v[36:39] offset:21504
  ds_write_b128 v15, v[40:43] offset:22528
  ds_write_b128 v15, v[44:47] offset:23552
  ds_write_b128 v15, v[48:51] offset:24576
  ds_write_b128 v15, v[52:55] offset:25600
  ds_write_b128 v15, v[56:59] offset:26624
  ds_write_b128 v15, v[60:63] offset:27648
  ds_write_b128 v15, v[64:67] offset:28672
  ds_write_b128 v15, v[68:71] offset:29696
  ds_write_b128 v15, v[72:75] offset:30720
  ds_write_b128 v15, v[76:79] offset:31744
  s_waitcnt lgkmcnt(0)
  v_mov_b32 v9, v119
  v_mov_b64 v[22:23], 0
  v_accvgpr_read_b32 v40, a144
  v_accvgpr_read_b32 v41, a145
  v_accvgpr_read_b32 v42, a146
  v_accvgpr_read_b32 v43, a147
  v_accvgpr_read_b32 v44, a148
  v_accvgpr_read_b32 v45, a149
  v_accvgpr_read_b32 v46, a150
  v_accvgpr_read_b32 v47, a151
  v_mov_b32 v122, 208
  s_branch L_nonce_14
L_nonce_13:
  s_sub_u32 s100, s100, 1
  s_cbranch_scc1 L_end
  global_load_dwordx2 v[124:125], v122, s[24:25] sc1
  s_waitcnt vmcnt(0)
L_nonce_14:
  v_readfirstlane_b32 s30, v124
  v_readfirstlane_b32 s31, v125
  s_mul_i32 s36, s30, 0x9E3779B1
  s_or_b32 s36, s36, 1
  s_cmp_eq_u32 s36, s31
  s_cbranch_scc0 L_nonce_13
  buffer_load_dwordx2 v[16:17], v8, s[8:11], s52 offen sc1
  s_waitcnt vmcnt(0)
  s_mov_b32 s37, 0
  v_subrev_u32 v10, s30, v16
  v_bfe_u32 v11, v8, 3, 2
  v_cmp_eq_u32 s[70:71], s31, v17
  v_mad_u32_u24 v10, v10, 3, v11
  s_add_u32 s48, s37, 1
  s_min_u32 s48, s48, 63
  v_cmp_lt_u32 s[38:39], 63, v10
  v_cmp_lt_u32 s[94:95], s48, v10
  v_cmp_lt_u32 vcc, s37, v10
  s_and_b32 s38, s38, s70
  s_andn2_b32 s60, 0x7777, s38
  s_andn2_b32 s38, 0x7777, s94
  s_cselect_b32 s32, -1, 0xffff0000
  s_and_b32 s38, vcc_lo, s70
  s_andn2_b32 s38, 0x7777, s38
  s_cbranch_scc0 L_T_k0
L_kvw_15:
  s_sub_u32 s100, s100, 1
  s_cbranch_scc1 L_end
  buffer_load_dwordx2 v[16:17], v8, s[8:11], s52 offen sc1
  s_waitcnt vmcnt(0)
  v_subrev_u32 v10, s30, v16
  v_bfe_u32 v11, v8, 3, 2
  v_cmp_eq_u32 s[70:71], s31, v17
  v_mad_u32_u24 v10, v10, 3, v11
  s_add_u32 s48, s37, 1
  s_min_u32 s48, s48, 63
  v_cmp_lt_u32 s[38:39], 63, v10
  v_cmp_lt_u32 s[94:95], s48, v10
  v_cmp_lt_u32 vcc, s37, v10
  s_and_b32 s38, s38, s70
  s_andn2_b32 s60, 0x7777, s38
  s_andn2_b32 s38, 0x7777, s94
  s_cselect_b32 s32, -1, 0xffff0000
  s_and_b32 s38, vcc_lo, s70
  s_andn2_b32 s38, 0x7777, s38
  s_cbranch_scc1 L_kvw_15
L_T_k0:
  s_lshl_b32 s49, s26, 11
  s_mov_b32 m0, s49
  s_nop 0
  buffer_load_dwordx4 v3, s[8:11], s41 offen sc1 lds
  buffer_load_dwordx4 v3, s[8:11], s41 offen offset:1024 sc1 lds
  s_mov_b64 exec, s[32:33]
  buffer_load_dwordx2 v[16:17], v14, s[8:11], 0 offen sc1
  s_mov_b64 exec, -1
  s_barrier
  ds_read_b64_tr_b16 v[48:49], v112 offset:0
  ds_read_b64_tr_b16 v[50:51], v112 offset:2048
  ds_read_b64_tr_b16 v[64:65], v113 offset:0
  ds_read_b64_tr_b16 v[66:67], v113 offset:2048
  ds_read_b64_tr_b16 v[52:53], v112 offset:256
  ds_read_b64_tr_b16 v[54:55], v112 offset:2304
  ds_read_b64_tr_b16 v[68:69], v113 offset:256
  ds_read_b64_tr_b16 v[70:71], v113 offset:2304
  ds_read_b64_tr_b16 v[56:57], v112 offset:512
  ds_read_b64_tr_b16 v[58:59], v112 offset:2560
  ds_read_b64_tr_b16 v[72:73], v113 offset:512
  ds_read_b64_tr_b16 v[74:75], v113 offset:2560
  ds_read_b64_tr_b16 v[60:61], v112 offset:768
  ds_read_b64_tr_b16 v[62:63], v112 offset:2816
  ds_read_b64_tr_b16 v[76:77], v113 offset:768
  ds_read_b64_tr_b16 v[78:79], v113 offset:2816
  ds_read_b64_tr_b16 a[144:145], v114 offset:0
  ds_read_b64_tr_b16 a[146:147], v114 offset:2048
  ds_read_b64_tr_b16 a[208:209], v115 offset:0
  ds_read_b64_tr_b16 a[210:211], v115 offset:2048
  ds_read_b64_tr_b16 a[148:149], v114 offset:256
  ds_read_b64_tr_b16 a[150:151], v114 offset:2304
  ds_read_b64_tr_b16 a[212:213], v115 offset:256
  ds_read_b64_tr_b16 a[214:215], v115 offset:2304
  ds_read_b64_tr_b16 a[152:153], v114 offset:512
  ds_read_b64_tr_b16 a[154:155], v114 offset:2560
  ds_read_b64_tr_b16 a[216:217], v115 offset:512
  ds_read_b64_tr_b16 a[218:219], v115 offset:2560
  ds_read_b64_tr_b16 a[156:157], v114 offset:768
  ds_read_b64_tr_b16 a[158:159], v114 offset:2816
  ds_read_b64_tr_b16 a[220:221], v115 offset:768
  ds_read_b64_tr_b16 a[222:223], v115 offset:2816
  s_waitcnt lgkmcnt(0)
  s_barrier
  ds_write_b128 v15, v[80:83] offset:8192
  ds_write_b128 v15, v[84:87] offset:9216
  ds_write_b128 v15, v[88:91] offset:10240
  ds_write_b128 v15, v[92:95] offset:11264
  ds_write_b128 v15, v[96:99] offset:12288
  ds_write_b128 v15, v[100:103] offset:13312
  ds_write_b128 v15, v[104:107] offset:14336
  ds_write_b128 v15, v[108:111] offset:15360
  ds_write_b128 v15, v[48:51] offset:0
  ds_write_b128 v15, v[52:55] offset:1024
  ds_write_b128 v15, v[56:59] offset:2048
  ds_write_b128 v15, v[60:63] offset:3072
  ds_write_b128 v15, v[64:67] offset:4096
  ds_write_b128 v15, v[68:71] offset:5120
  ds_write_b128 v15, v[72:75] offset:6144
  ds_write_b128 v15, v[76:79] offset:7168
  v_mov_b32 v124, 192
  s_branch L_T_bar2
L_T_bar:
  s_sub_u32 s100, s100, 1
  s_cbranch_scc1 L_end
  global_load_dwordx2 v[120:121], v124, s[24:25] sc1
  s_waitcnt vmcnt(0)
L_T_bar2:
  v_readfirstlane_b32 s96, v120
  v_readfirstlane_b32 s97, v121
  s_and_b32 s37, s96, 0xffff
  s_cmp_lt_u32 s37, 32
  s_cbranch_scc1 L_T_bar
  s_cmp_lt_u32 s97, 16
  s_cbranch_scc1 L_T_bar
  s_lshr_b32 s29, s96, 16
  s_waitcnt lgkmcnt(0)
  s_lshl_b32 s50, s26, 11
  ds_read_b128 v[48:51], v15 offset:8192
  ds_read_b128 v[52:55], v15 offset:9216
  ds_read_b128 v[56:59], v15 offset:12288
  ds_read_b128 v[60:63], v15 offset:13312
  ds_read_b128 v[64:67], v15 offset:0
  ds_read_b128 v[68:71], v15 offset:1024
  ds_read_b128 v[32:35], v15 offset:4096
  ds_read_b128 v[36:39], v15 offset:5120
  ds_read_b128 v[96:99], v15 offset:10240
  ds_read_b128 v[100:103], v15 offset:11264
  ds_read_b128 v[104:107], v15 offset:14336
  ds_read_b128 v[108:111], v15 offset:15360
  ds_read_b128 v[112:115], v15 offset:2048
  ds_read_b128 v[116:119], v15 offset:3072
  ds_read_b128 v[120:123], v15 offset:6144
  ds_read_b128 v[124:127], v15 offset:7168
  v_min_u32 v40, -2, v40
  v_min_u32 v41, -2, v41
  v_min_u32 v42, -2, v42
  v_min_u32 v43, -2, v43
  v_min_u32 v44, -2, v44
  v_min_u32 v45, -2, v45
  v_min_u32 v46, -2, v46
  v_min_u32 v47, -2, v47
  v_mov_b64 v[72:73], 0
  v_mov_b64 v[74:75], 0
  v_mov_b64 v[76:77], 0
  v_mov_b64 v[78:79], 0
  v_mov_b64 v[80:81], 0
  v_mov_b64 v[82:83], 0
  v_mov_b64 v[84:85], 0
  v_mov_b64 v[86:87], 0
  v_mov_b64 v[88:89], 0
  v_mov_b64 v[90:91], 0
  v_mov_b64 v[92:93], 0
  v_mov_b64 v[94:95], 0
  s_waitcnt vmcnt(0)
  s_add_u32 s49, s40, 1
  s_min_u32 s49, s49, 63
  v_subrev_u32 v10, s30, v16
  v_bfe_u32 v11, v8, 3, 2
  v_cmp_eq_u32 s[70:71], s31, v17
  v_mad_u32_u24 v10, v10, 3, v11
  s_add_u32 s48, s49, 1
  s_min_u32 s48, s48, 63
  v_cmp_lt_u32 s[38:39], 63, v10
  v_cmp_lt_u32 s[94:95], s48, v10
  v_cmp_lt_u32 vcc, s49, v10
  s_and_b32 s38, s38, s70
  s_andn2_b32 s60, 0x7777, s38
  s_andn2_b32 s38, 0x7777, s94
  s_cselect_b32 s32, -1, 0xffff0000
  s_and_b32 s38, vcc_lo, s70
  s_andn2_b32 s38, 0x7777, s38
  s_cbranch_scc0 L_kvok_16
L_kvw_17:
  s_sub_u32 s100, s100, 1
  s_cbranch_scc1 L_end
  buffer_load_dwordx2 v[16:17], v8, s[8:11], s52 offen sc1
  s_waitcnt vmcnt(0)
  v_subrev_u32 v10, s30, v16
  v_bfe_u32 v11, v8, 3, 2
  v_cmp_eq_u32 s[70:71], s31, v17
  v_mad_u32_u24 v10, v10, 3, v11
  s_add_u32 s48, s49, 1
  s_min_u32 s48, s48, 63
  v_cmp_lt_u32 s[38:39], 63, v10
  v_cmp_lt_u32 s[94:95], s48, v10
  v_cmp_lt_u32 vcc, s49, v10
  s_and_b32 s38, s38, s70
  s_andn2_b32 s60, 0x7777, s38
  s_andn2_b32 s38, 0x7777, s94
  s_cselect_b32 s32, -1, 0xffff0000
  s_and_b32 s38, vcc_lo, s70
  s_andn2_b32 s38, 0x7777, s38
  s_cbranch_scc1 L_kvw_17
L_kvok_16:
  s_add_u32 s55, s41, 8192
  s_cmp_lt_u32 s40, 63
  s_cselect_b32 s48, 524288, 0
  s_add_u32 s41, s41, s48
  s_xor_b32 s50, s50, 81920
  s_nop 0
  s_mov_b32 exec_lo, 0xffff0000
  v_add_u32 v14, s48, v14
  s_mov_b32 exec_lo, -1
  s_waitcnt vmcnt(0) lgkmcnt(0)
  s_cmp_lg_u32 s29, 0
  s_cbranch_scc1 L_T_loop_x
  s_branch L_T_loop_f
L_T_r2_f:
  s_mov_b64 exec, s[90:91]
  buffer_load_dwordx4 v[40:43], v3, s[8:11], s45 offen sc1
  s_mov_b64 exec, s[92:93]
  buffer_load_dwordx4 v[44:47], v3, s[8:11], s45 offen offset:1024 sc1
  s_mov_b64 exec, -1
  s_sub_u32 s100, s100, 1
  s_cbranch_scc1 L_end
L_T_r2a_f:
  v_mov_b64 v[72:73], 0
  v_mov_b64 v[74:75], 0
  v_mov_b64 v[76:77], 0
  v_mov_b64 v[78:79], 0
  s_waitcnt vmcnt(3)
  v_max3_u32 v10, v40, v41, v42
  v_max_u32 v10, v43, v10
  v_smfmac_f32_16x16x64_bf16 v[72:75], v[40:43], v[48:55], v1
  ds_write_b128 v3, v[40:43] offset:40960
  s_waitcnt vmcnt(2)
  v_max3_u32 v11, v44, v45, v46
  v_max_u32 v11, v47, v11
  v_cmp_eq_u32 s[90:91], -1, v10
  v_cmp_eq_u32 s[92:93], -1, v11
  v_smfmac_f32_16x16x64_bf16 v[76:79], v[40:43], v[56:63], v1
  s_or_b64 s[94:95], s[90:91], s[92:93]
  s_cbranch_scc1 L_T_r2_f
  ds_write_b128 v3, v[44:47] offset:41984
  s_branch L_T_e_f
L_T_first_f:
  v_smfmac_f32_16x16x64_bf16 v[72:75], v[40:43], v[48:55], v1
  ds_write_b128 v3, v[40:43] offset:40960
  v_smfmac_f32_16x16x64_bf16 v[76:79], v[40:43], v[56:63], v1
  ds_write_b128 v3, v[44:47] offset:41984
  s_branch L_T_e_f
.p2align 6
L_T_p2_f:
L_T_loop_f:
  s_waitcnt vmcnt(3)
  v_max3_u32 v10, v40, v41, v42
  v_max_u32 v10, v43, v10
  v_smfmac_f32_16x16x64_bf16 v[72:75], v[40:43], v[48:55], v1
  ds_write_b128 v3, v[40:43] offset:40960
  s_waitcnt vmcnt(2)
  v_max3_u32 v11, v44, v45, v46
  v_max_u32 v11, v47, v11
  v_cmp_eq_u32 s[90:91], -1, v10
  v_cmp_eq_u32 s[92:93], -1, v11
  v_smfmac_f32_16x16x64_bf16 v[76:79], v[40:43], v[56:63], v1
  s_or_b64 s[94:95], s[90:91], s[92:93]
  s_cbranch_scc1 L_T_r2_f
L_T_w1_f:
  ds_write_b128 v3, v[44:47] offset:41984
L_T_e_f:
  v_smfmac_f32_16x16x64_bf16 v[80:83], v[40:43], v[64:71], v1
  s_add_u32 s45, s45, 0x2000
  s_andn2_b32 s45, s45, 0x8000
  s_xor_b32 s46, s45, 0x4000
  v_smfmac_f32_16x16x64_bf16 v[84:87], v[40:43], v[32:39], v1
  v_mov_b64_e64 v[24:25], -1
  v_smfmac_f32_16x16x64_bf16 v[72:75], v[44:47], v[96:103], v1
  v_mov_b64_e64 v[26:27], -1
  v_smfmac_f32_16x16x64_bf16 v[76:79], v[44:47], v[104:111], v1
  v_smfmac_f32_16x16x64_bf16 v[80:83], v[44:47], v[112:119], v1
  buffer_store_dwordx4 v[24:27], v3, s[8:11], s44 offen offset:1024
  v_smfmac_f32_16x16x64_bf16 v[84:87], v[44:47], v[120:127], v1
  buffer_store_dwordx4 v[24:27], v3, s[8:11], s44 offen
  s_waitcnt lgkmcnt(0)
  s_barrier
  ds_read_b128 v[48:51], v4 offset:40960
  ds_read_b128 v[52:55], v4 offset:41984
  v_smfmac_f32_16x16x64_bf16 v[88:91], v[40:43], v[128:135], v1
  ds_read_b128 v[56:59], v5 offset:40960
  s_mov_b32 m0, s50
  v_smfmac_f32_16x16x64_bf16 v[92:95], v[40:43], v[192:199], v1
  ds_read_b128 v[60:63], v5 offset:41984
  s_cmp_eq_u32 s40, 63
  v_smfmac_f32_16x16x64_bf16 v[88:91], v[44:47], v[136:143], v1
  ds_read_b128 v[64:67], v6 offset:40960
  v_smfmac_f32_16x16x64_bf16 v[92:95], v[44:47], v[200:207], v1
  ds_read_b128 v[68:71], v6 offset:41984
  s_cbranch_scc1 L_T_fin
  s_waitcnt lgkmcnt(5)
  v_smfmac_f32_16x16x64_bf16 v[72:75], v[48:51], a[16:23], v1
  buffer_load_dwordx4 v[24:27], v3, s[8:11], s55 offen offset:0 sc1
  v_smfmac_f32_16x16x64_bf16 v[76:79], v[48:51], a[80:87], v1
  s_waitcnt lgkmcnt(4)
  v_smfmac_f32_16x16x64_bf16 v[72:75], v[52:55], a[24:31], v1
  buffer_load_dwordx4 v[28:31], v3, s[8:11], s55 offen offset:1024 sc1
  v_smfmac_f32_16x16x64_bf16 v[76:79], v[52:55], a[88:95], v1
  s_waitcnt lgkmcnt(3)
  v_smfmac_f32_16x16x64_bf16 v[72:75], v[56:59], a[32:39], v1
  buffer_load_dwordx4 v3, s[8:11], s41 offen sc1 lds
  v_smfmac_f32_16x16x64_bf16 v[76:79], v[56:59], a[96:103], v1
  s_waitcnt lgkmcnt(2)
  v_smfmac_f32_16x16x64_bf16 v[72:75], v[60:63], a[40:47], v1
  buffer_load_dwordx4 v3, s[8:11], s41 offen offset:1024 sc1 lds
  v_smfmac_f32_16x16x64_bf16 v[76:79], v[60:63], a[104:111], v1
  s_waitcnt lgkmcnt(1)
  v_smfmac_f32_16x16x64_bf16 v[72:75], v[64:67], a[48:55], v1
  s_mov_b64 exec, s[32:33]
  buffer_load_dwordx2 v[16:17], v14, s[8:11], 0 offen sc1
  s_mov_b64 exec, -1
  v_smfmac_f32_16x16x64_bf16 v[76:79], v[64:67], a[112:119], v1
  buffer_store_dwordx4 v[18:21], v3, s[8:11], s42 offen sc1
  s_add_u32 s42, s42, 131072
  s_waitcnt lgkmcnt(0)
  v_smfmac_f32_16x16x64_bf16 v[72:75], v[68:71], a[56:63], v1
  ds_read_b128 v[96:99], v2 offset:0
  v_smfmac_f32_16x16x64_bf16 v[76:79], v[68:71], a[120:127], v1
  ds_read_b128 v[100:103], v2 offset:1024
  v_smfmac_f32_16x16x64_bf16 v[80:83], v[48:51], a[144:151], v1
  ds_read_b128 v[104:107], v2 offset:2048
  v_mov_b64 v[32:33], 0
  v_smfmac_f32_16x16x64_bf16 v[84:87], v[48:51], a[208:215], v1
  ds_read_b128 v[108:111], v2 offset:3072
  v_add_f32_e64 v72, v72, v74
  v_smfmac_f32_16x16x64_bf16 v[80:83], v[52:55], a[152:159], v1
  ds_read_b128 v[112:115], v2 offset:4096
  v_add_f32_e64 v73, v73, v75
  v_smfmac_f32_16x16x64_bf16 v[84:87], v[52:55], a[216:223], v1
  ds_read_b128 v[116:119], v2 offset:5120
  v_add_f32_e64 v76, v76, v78
  v_smfmac_f32_16x16x64_bf16 v[80:83], v[56:59], a[160:167], v1
  ds_read_b128 v[120:123], v2 offset:6144
  v_add_f32_e64 v77, v77, v79
  v_smfmac_f32_16x16x64_bf16 v[84:87], v[56:59], a[224:231], v1
  ds_read_b128 v[124:127], v2 offset:7168
  v_cvt_pk_bf16_f32 v72, v72, v73
  v_smfmac_f32_16x16x64_bf16 v[80:83], v[60:63], a[168:175], v1
  ds_write2_b32 v7, v72, v72 offset0:0 offset1:1
  v_cvt_pk_bf16_f32 v76, v76, v77
  v_smfmac_f32_16x16x64_bf16 v[84:87], v[60:63], a[232:239], v1
  ds_write2_b32 v7, v76, v76 offset0:128 offset1:129
  v_mov_b64_e64 v[34:35], 0
  v_smfmac_f32_16x16x64_bf16 v[80:83], v[64:67], a[176:183], v1
  v_mov_b32 v36, 0x3f803f80
  v_smfmac_f32_16x16x64_bf16 v[84:87], v[64:67], a[240:247], v1
  v_mov_b32 v37, 0x3f803f80
  v_smfmac_f32_16x16x64_bf16 v[80:83], v[68:71], a[184:191], v1
  v_mov_b32 v38, 0x3f803f80
  v_smfmac_f32_16x16x64_bf16 v[84:87], v[68:71], a[248:255], v1
  s_nop 0
  s_nop 0
  v_mov_b32 v39, 0x3f803f80
  v_smfmac_f32_16x16x64_bf16 v[88:91], v[48:51], v[144:151], v1
  s_nop 1
  v_add_f32 v80, v80, v82
  v_add_f32 v81, v81, v83
  v_add_f32 v84, v84, v86
  v_add_f32_e64 v85, v85, v87
  v_cvt_pk_bf16_f32 v18, v80, v81
  v_cvt_pk_bf16_f32 v19, v84, v85
  v_smfmac_f32_16x16x64_bf16 v[92:95], v[48:51], v[208:215], v1
  ds_write2st64_b32 v7, v18, v19 offset0:16 offset1:18
  v_smfmac_f32_16x16x64_bf16 v[88:91], v[52:55], v[152:159], v1
  v_smfmac_f32_16x16x64_bf16 v[92:95], v[52:55], v[216:223], v1
  v_smfmac_f32_16x16x64_bf16 v[88:91], v[56:59], v[160:167], v1
  v_smfmac_f32_16x16x64_bf16 v[92:95], v[56:59], v[224:231], v1
  s_waitcnt vmcnt(4)
  v_smfmac_f32_16x16x64_bf16 v[88:91], v[60:63], v[168:175], v1
  s_waitcnt lgkmcnt(0)
  s_barrier
  ds_read_b64_tr_b16 v[72:73], v8 offset:0
  ds_read_b64_tr_b16 v[74:75], v8 offset:512
  v_smfmac_f32_16x16x64_bf16 v[92:95], v[60:63], v[232:239], v1
  ds_read_b64_tr_b16 v[76:77], v8 offset:1024
  ds_read_b64_tr_b16 v[78:79], v8 offset:1536
  v_smfmac_f32_16x16x64_bf16 v[88:91], v[64:67], v[176:183], v1
  ds_read_b64_tr_b16 v[80:81], v8 offset:2048
  ds_read_b64_tr_b16 v[82:83], v8 offset:2560
  v_smfmac_f32_16x16x64_bf16 v[92:95], v[64:67], v[240:247], v1
  ds_read_b64_tr_b16 v[84:85], v8 offset:3072
  ds_read_b64_tr_b16 v[86:87], v8 offset:3584
  v_smfmac_f32_16x16x64_bf16 v[88:91], v[68:71], v[184:191], v1
  ds_read_b64_tr_b16 v[40:41], v8 offset:4096
  v_smfmac_f32_16x16x64_bf16 v[92:95], v[68:71], v[248:255], v1
  ds_read_b64_tr_b16 v[42:43], v8 offset:4608
  s_waitcnt lgkmcnt(6)
  v_mfma_f32_16x16x32_bf16 v[56:59], v[96:99], v[72:75], 0
  ds_read_b64_tr_b16 v[44:45], v8 offset:5120
  v_add_u32_e64 v11, s56, v2
  v_mfma_f32_16x16x32_bf16 v[60:63], v[112:115], v[72:75], 0
  ds_read_b64_tr_b16 v[46:47], v8 offset:5632
  v_mov_b64_e64 v[96:97], 0
  v_mfma_f32_16x16x32_bf16 v[56:59], v[100:103], v[76:79], v[56:59]
  ds_read_b64_tr_b16 v[48:49], v8 offset:6144
  v_mov_b64_e64 v[98:99], 0
  v_mfma_f32_16x16x32_bf16 v[60:63], v[116:119], v[76:79], v[60:63]
  ds_read_b64_tr_b16 v[50:51], v8 offset:6656
  s_waitcnt lgkmcnt(6)
  v_mfma_f32_16x16x32_bf16 v[56:59], v[104:107], v[80:83], v[56:59]
  ds_read_b64_tr_b16 v[52:53], v8 offset:7168
  v_mov_b64 v[100:101], 0
  v_mfma_f32_16x16x32_bf16 v[60:63], v[120:123], v[80:83], v[60:63]
  ds_read_b64_tr_b16 v[54:55], v8 offset:7680
  v_mov_b64_e64 v[102:103], 0
  v_mfma_f32_16x16x32_bf16 v[56:59], v[108:111], v[84:87], v[56:59]
  v_add_f32 v88, v88, v90
  v_add_f32 v89, v89, v91
  v_mfma_f32_16x16x32_bf16 v[60:63], v[124:127], v[84:87], v[60:63]
  s_waitcnt lgkmcnt(4)
  v_add_f32 v92, v92, v94
  v_add_f32_e64 v93, v93, v95
  v_mfma_f32_16x16x32_bf16 v[64:67], v[40:43], v[72:75], 0
  v_cvt_pk_bf16_f32 v20, v88, v89
  v_cvt_pk_bf16_f32 v21, v92, v93
  v_mfma_f32_16x16x32_bf16 v[64:67], v[44:47], v[76:79], v[64:67]
  s_waitcnt lgkmcnt(2)
  v_mfma_f32_16x16x32_bf16 v[64:67], v[48:51], v[80:83], v[64:67]
  s_waitcnt lgkmcnt(0)
  v_max3_f32 v92, v56, v57, v58
  v_max3_f32 v92, v59, v60, v92
  v_mfma_f32_16x16x32_bf16 v[64:67], v[52:55], v[84:87], v[64:67]
  s_add_u32 s40, s40, 1
  v_max3_f32 v92, v61, v62, v92
  v_max_f32 v92, v63, v92
  v_mov_b64 v[104:105], 0
  v_mov_b64 v[106:107], 0
  v_mov_b64 v[108:109], 0
  v_mov_b64_e64 v[110:111], 0
  s_nop 0
  v_max3_f32 v66, v64, v65, v92
  v_max3_f32 v67, v64, v65, v92
  v_mov_b64 v[88:89], 0
  v_mov_b64 v[90:91], 0
  v_permlane16_swap_b32 v66, v67
  v_max_f32 v92, v66, v67
  v_max_f32 v93, v66, v67
  v_mov_b64 v[72:73], -1
  v_mov_b64 v[74:75], -1
  v_permlane32_swap_b32 v92, v93
  v_max_f32 v66, v92, v93
  v_mul_f32 v66, s47, v66
  v_pk_fma_f32 v[64:65], v[64:65], s[66:67], v[66:67] op_sel_hi:[1,1,0]
  v_pk_fma_f32 v[56:57], v[56:57], s[66:67], v[66:67] op_sel_hi:[1,1,0]
  v_pk_fma_f32 v[58:59], v[58:59], s[66:67], v[66:67] op_sel_hi:[1,1,0]
  v_pk_fma_f32 v[60:61], v[60:61], s[66:67], v[66:67] op_sel_hi:[1,1,0]
  v_pk_fma_f32 v[62:63], v[62:63], s[66:67], v[66:67] op_sel_hi:[1,1,0]
  v_exp_f32 v64, v64
  v_exp_f32 v65, v65
  v_exp_f32_e64 v56, v56
  v_cvt_pk_bf16_f32 v66, v64, v65
  v_cndmask_b32 v32, 0, v66, s[62:63]
  v_cndmask_b32 v33, 0, v66, s[64:65]
  v_exp_f32 v57, v57
  v_exp_f32 v58, v58
  v_mfma_f32_16x16x32_bf16 v[68:71], v[36:39], v[32:35], 0
  ds_read_b128 v[112:115], v15 offset:16384
  v_exp_f32 v59, v59
  v_exp_f32 v60, v60
  v_mfma_f32_16x16x32_bf16 v[92:95], v[20:23], v[32:35], 0
  ds_read_b128 v[116:119], v15 offset:17408
  v_exp_f32 v61, v61
  v_exp_f32 v62, v62
  v_exp_f32 v63, v63
  s_mov_b64 exec, s[62:63]
  v_cvt_pk_bf16_f32 v96, v56, v57
  v_cvt_pk_bf16_f32 v97, v58, v59
  v_cvt_pk_bf16_f32 v98, v60, v61
  v_cvt_pk_bf16_f32 v99, v62, v63
  s_mov_b64 exec, s[64:65]
  v_cvt_pk_bf16_f32 v100, v56, v57
  v_mfma_f32_16x16x32_bf16 v[68:71], v[36:39], v[96:99], v[68:71]
  v_cvt_pk_bf16_f32 v101, v58, v59
  v_cvt_pk_bf16_f32 v102, v60, v61
  v_mfma_f32_16x16x32_bf16 v[92:95], v[24:27], v[96:99], v[92:95]
  v_cvt_pk_bf16_f32 v103, v62, v63
  s_mov_b64 exec, -1
  s_nop 0
  v_mfma_f32_16x16x32_bf16 v[92:95], v[28:31], v[100:103], v[92:95]
  s_nop 0
  v_rcp_f32_dpp v68, v68 quad_perm:[0,1,0,1] row_mask:0xf bank_mask:0xf
  v_mov_b64 v[64:65], 0
  v_mov_b64 v[66:67], 0
  v_mov_b64 v[96:97], 0
  v_mov_b64 v[98:99], 0
  v_mov_b64 v[100:101], 0
  v_mov_b64 v[102:103], 0
  v_pk_mul_f32 v[92:93], v[92:93], v[68:69] op_sel_hi:[1,0]
  v_pk_mul_f32 v[94:95], v[94:95], v[68:69] op_sel_hi:[1,0]
  v_cvt_pk_bf16_f32 v56, v92, v93
  v_cvt_pk_bf16_f32 v57, v94, v95
  ds_write_b64 v11, v[56:57]
  ds_read_b128 v[120:123], v15 offset:18432
  ds_read_b128 v[124:127], v15 offset:19456
  v_mov_b64 v[92:93], 0
  v_mov_b64_e64 v[94:95], 0
  s_nop 1
  ds_read_b128 v[40:43], v15 offset:20480
  ds_read_b128 v[44:47], v15 offset:21504
  v_mov_b64 v[68:69], 0
  v_mov_b64 v[70:71], 0
  s_waitcnt lgkmcnt(4)
  s_barrier
  ds_read_b128 v[56:59], v2 offset:0
  ds_read_b128 v[60:63], v2 offset:1024
  v_mov_b32 v0, v22
  s_mov_b64 exec, s[68:69]
  buffer_store_dword v72, v13, s[8:11], s46 offen
  s_mov_b64 exec, -1
  ds_read_b128 v[48:51], v15 offset:22528
  ds_read_b128 v[52:55], v15 offset:23552
  v_mov_b32_e64 v0, v22
  s_waitcnt lgkmcnt(3)
  v_smfmac_f32_16x16x64_bf16 v[104:107], v[56:59], a[0:7], v1
  ds_read_b128 v[72:75], v15 offset:24576
  s_waitcnt lgkmcnt(3)
  v_smfmac_f32_16x16x64_bf16 v[104:107], v[60:63], a[64:71], v1
  ds_read_b128 v[76:79], v15 offset:25600
  v_xor_b32 v2, 81920, v2
  v_smfmac_f32_16x16x64_bf16 v[108:111], v[56:59], a[128:135], v1
  ds_read_b128 v[80:83], v15 offset:26624
  v_smfmac_f32_16x16x64_bf16 v[108:111], v[60:63], a[192:199], v1
  ds_read_b128 v[84:87], v15 offset:27648
  v_smfmac_f32_16x16x64_bf16 v[88:91], v[56:59], a[8:15], v1
  ds_read_b128 v[24:27], v15 offset:28672
  v_add_f32 v104, v104, v106
  v_smfmac_f32_16x16x64_bf16 v[88:91], v[60:63], a[72:79], v1
  ds_read_b128 v[28:31], v15 offset:29696
  v_add_f32_e64 v105, v105, v107
  v_smfmac_f32_16x16x64_bf16 v[64:67], v[56:59], a[136:143], v1
  ds_read_b128 v[32:35], v15 offset:30720
  v_add_f32 v108, v108, v110
  v_add_f32 v109, v109, v111
  v_smfmac_f32_16x16x64_bf16 v[64:67], v[60:63], a[200:207], v1
  ds_read_b128 v[36:39], v15 offset:31744
  v_cvt_pk_bf16_f32 v104, v104, v108
  v_cvt_pk_bf16_f32 v105, v105, v109
  v_smfmac_f32_16x16x64_bf16 v[96:99], v[56:59], v[112:119], v1
  buffer_store_dwordx2 v[104:105], v12, s[8:11], s43 offen
  v_add_f32 v88, v88, v90
  v_add_f32 v89, v89, v91
  v_smfmac_f32_16x16x64_bf16 v[96:99], v[60:63], v[120:127], v1
  s_waitcnt lgkmcnt(6)
  s_nop 0
  v_add_f32 v64, v64, v66
  v_add_f32 v65, v65, v67
  v_smfmac_f32_16x16x64_bf16 v[100:103], v[56:59], v[40:47], v1
  s_nop 0
  s_nop 0
  v_cvt_pk_bf16_f32 v88, v88, v64
  v_cvt_pk_bf16_f32 v89, v89, v65
  v_smfmac_f32_16x16x64_bf16 v[100:103], v[60:63], v[48:55], v1
  buffer_store_dwordx2 v[88:89], v12, s[8:11], s53 offen
  s_nop 0
  v_add_f32 v96, v96, v98
  v_smfmac_f32_16x16x64_bf16 v[92:95], v[56:59], v[72:79], v1
  s_waitcnt lgkmcnt(2)
  s_nop 0
  v_add_f32_e64 v97, v97, v99
  v_smfmac_f32_16x16x64_bf16 v[92:95], v[60:63], v[80:87], v1
  s_nop 1
  v_add_f32 v100, v100, v102
  v_add_f32_e64 v101, v101, v103
  v_smfmac_f32_16x16x64_bf16 v[68:71], v[56:59], v[24:31], v1
  s_waitcnt lgkmcnt(0)
  s_nop 0
  v_cvt_pk_bf16_f32 v96, v96, v100
  v_cvt_pk_bf16_f32 v97, v97, v101
  v_smfmac_f32_16x16x64_bf16 v[68:71], v[60:63], v[32:39], v1
  buffer_store_dwordx2 v[96:97], v12, s[8:11], s51 offen
  v_add_f32 v92, v92, v94
  v_add_f32 v93, v93, v95
  s_nop 4
  v_add_f32 v68, v68, v70
  v_add_f32_e64 v69, v69, v71
  v_cvt_pk_bf16_f32 v92, v92, v68
  v_cvt_pk_bf16_f32 v93, v93, v69
  buffer_store_dwordx2 v[92:93], v12, s[8:11], s57 offen
  s_barrier
  v_mov_b64 v[40:41], 0
  v_mov_b64_e64 v[42:43], 0
  s_xor_b32 s43, s43, 0x40000
  s_xor_b32 s53, s53, 0x40000
  s_xor_b32 s51, s51, 0x40000
  ds_read_b128 v[48:51], v15 offset:8192
  ds_read_b128 v[52:55], v15 offset:9216
  s_nop 0
  v_mov_b64 v[72:73], 0
  v_mov_b64_e64 v[74:75], 0
  s_xor_b32 s57, s57, 0x40000
  s_xor_b32 s44, s44, 0x40000
  s_nop 0
  ds_read_b128 v[56:59], v15 offset:12288
  ds_read_b128 v[60:63], v15 offset:13312
  s_nop 0
  v_mov_b32_dpp v40, v9 quad_perm:[0,1,2,3] row_mask:0xf bank_mask:0x1
  v_mov_b32_dpp v41, v9 quad_perm:[0,1,2,3] row_mask:0xf bank_mask:0x2
  s_nop 1
  s_cmp_le_u32 s26, 0
  s_cbranch_scc1 L_T_sg_f
  v_mov_b32 v0, v22
  s_nop 3
  s_cmp_le_u32 s26, 1
  s_cbranch_scc1 L_T_sg_f
  v_mov_b32 v0, v22
  s_nop 3
  s_cmp_le_u32 s26, 2
  s_cbranch_scc1 L_T_sg_f
  v_mov_b32_e64 v0, v22
  s_nop 3
L_T_sg_f:
  buffer_load_dwordx4 v[24:27], v3, s[8:11], s54 offen sc1
  buffer_load_dwordx4 v[28:31], v3, s[8:11], s54 offen offset:1024 sc1
  v_mov_b32_dpp v42, v9 quad_perm:[0,1,2,3] row_mask:0xf bank_mask:0x4
  v_mov_b32_dpp v43, v9 quad_perm:[0,1,2,3] row_mask:0xf bank_mask:0x8
  s_add_u32 s55, s41, 8192
  s_cmp_lt_u32 s40, 63
  s_cselect_b32 s48, 524288, 0
  ds_read_b128 v[64:67], v15 offset:0
  ds_read_b128 v[68:71], v15 offset:1024
  s_nop 0
  v_mov_b64 v[76:77], 0
  v_mov_b64_e64 v[78:79], 0
  s_add_u32 s41, s41, s48
  s_xor_b32 s50, s50, 81920
  s_nop 0
  ds_read_b128 v[32:35], v15 offset:4096
  ds_read_b128 v[36:39], v15 offset:5120
  s_nop 0
  v_mov_b64 v[80:81], 0
  v_mov_b64 v[82:83], 0
  s_mov_b32 exec_lo, 0xffff0000
  v_add_u32 v14, s48, v14
  s_mov_b32 exec_lo, -1
  ds_read_b128 v[96:99], v15 offset:10240
  ds_read_b128 v[100:103], v15 offset:11264
  s_nop 0
  v_mov_b64 v[84:85], 0
  v_mov_b64_e64 v[86:87], 0
  s_nop 1
  s_mov_b64 exec, s[34:35]
  buffer_load_dwordx4 v[24:27], v3, s[8:11], s54 offen sc1
  buffer_load_dwordx4 v[28:31], v3, s[8:11], s54 offen offset:1024 sc1
  s_mov_b64 exec, -1
  v_mov_b64 v[88:89], 0
  v_mov_b64 v[90:91], 0
  s_nop 2
  ds_read_b128 v[104:107], v15 offset:14336
  ds_read_b128 v[108:111], v15 offset:15360
  s_nop 0
  s_waitcnt vmcnt(3)
  v_max3_u32 v10, v24, v25, v26
  v_max_u32_e64 v10, v27, v10
  v_mfma_f32_16x16x32_bf16 v[44:47], v[40:43], v[24:27], 0
  s_waitcnt vmcnt(2)
  v_max3_u32 v11, v28, v29, v30
  v_max_u32 v11, v31, v11
  v_mfma_f32_16x16x32_bf16 v[44:47], v[40:43], v[28:31], v[44:47]
  v_cmp_eq_u32 s[90:91], -1, v10
  v_cmp_eq_u32 s[92:93], -1, v11
  s_nop 0
  s_or_b64 s[94:95], s[90:91], s[92:93]
  s_cbranch_scc1 L_T_r1_f
L_T_g1_f:
  s_nop 2
  v_add_f32_dpp v44, v44, v44 row_ror:8 row_mask:0xf bank_mask:0xf
  v_add_f32_dpp v45, v45, v45 row_ror:8 row_mask:0xf bank_mask:0xf
  s_nop 0
  v_add_f32_dpp v44, v44, v44 row_ror:4 row_mask:0xf bank_mask:0xf
  v_add_f32_dpp v45, v45, v45 row_ror:4 row_mask:0xf bank_mask:0xf
  s_mov_b64 exec, s[68:69]
  v_cvt_pk_bf16_f32 v10, v44, v45
  buffer_store_dword v10, v13, s[8:11], s45 offen
  s_mov_b64 exec, -1
  s_barrier
  s_xor_b32 s54, s54, 0x40000
  s_nop 0
  s_nop 0
  v_mov_b64 v[92:93], 0
  v_mov_b64_e64 v[94:95], 0
  s_nop 2
  ds_read_b128 v[112:115], v15 offset:2048
  ds_read_b128 v[116:119], v15 offset:3072
  s_nop 0
  v_mov_b32 v0, v22
  v_mov_b32 v0, v22
  s_nop 2
  ds_read_b128 v[120:123], v15 offset:6144
  ds_read_b128 v[124:127], v15 offset:7168
  s_nop 0
  v_mov_b32_e64 v0, v22
  s_nop 2
  buffer_load_dwordx4 v[40:43], v3, s[8:11], s45 offen sc1
  buffer_load_dwordx4 v[44:47], v3, s[8:11], s45 offen offset:1024 sc1
  s_cmp_lg_u32 s60, 0
  s_cbranch_scc1 L_T_chk_f
  v_mov_b32 v0, v22
  s_nop 2
  v_mov_b32 v0, v22
  s_nop 2
  v_mov_b32 v0, v22
  s_nop 2
  v_mov_b32 v0, v22
  s_nop 2
  v_mov_b32 v0, v22
  s_nop 2
  v_mov_b32 v0, v22
  s_nop 2
  v_mov_b32 v0, v22
  s_nop 2
  v_mov_b32 v0, v22
  s_nop 2
L_T_chkb_f:
  buffer_load_dwordx4 v[40:43], v3, s[8:11], s45 offen sc1
  buffer_load_dwordx4 v[44:47], v3, s[8:11], s45 offen offset:1024 sc1
  s_waitcnt lgkmcnt(0)
  s_branch L_T_p2_f
L_T_r1_f:
  s_mov_b64 exec, s[90:91]
  buffer_load_dwordx4 v[24:27], v3, s[8:11], s54 offen sc1
  s_mov_b64 exec, s[92:93]
  buffer_load_dwordx4 v[28:31], v3, s[8:11], s54 offen offset:1024 sc1
  s_mov_b64 exec, -1
  s_sub_u32 s100, s100, 1
  s_cbranch_scc1 L_end
L_T_r1a_f:
  v_mov_b32 v0, v22
  s_waitcnt vmcnt(3)
  v_max3_u32 v10, v24, v25, v26
  v_max_u32 v10, v27, v10
  v_mfma_f32_16x16x32_bf16 v[44:47], v[40:43], v[24:27], 0
  s_waitcnt vmcnt(2)
  v_max3_u32 v11, v28, v29, v30
  v_max_u32 v11, v31, v11
  v_mfma_f32_16x16x32_bf16 v[44:47], v[40:43], v[28:31], v[44:47]
  v_cmp_eq_u32 s[90:91], -1, v10
  v_cmp_eq_u32 s[92:93], -1, v11
  s_nop 0
  s_or_b64 s[94:95], s[90:91], s[92:93]
  s_cbranch_scc1 L_T_r1_f
  s_branch L_T_g1_f
L_T_chk_f:
  s_add_u32 s49, s40, 1
  s_min_u32 s49, s49, 63
  v_subrev_u32 v10, s30, v16
  v_bfe_u32 v11, v8, 3, 2
  v_cmp_eq_u32 s[70:71], s31, v17
  v_mad_u32_u24 v10, v10, 3, v11
  s_add_u32 s48, s49, 1
  s_min_u32 s48, s48, 63
  v_cmp_lt_u32 s[38:39], 63, v10
  v_cmp_lt_u32 s[94:95], s48, v10
  v_cmp_lt_u32 vcc, s49, v10
  s_and_b32 s38, s38, s70
  s_andn2_b32 s60, 0x7777, s38
  s_andn2_b32 s38, 0x7777, s94
  s_cselect_b32 s32, -1, 0xffff0000
  s_and_b32 s38, vcc_lo, s70
  s_andn2_b32 s38, 0x7777, s38
  s_cbranch_scc0 L_T_chkb_f
L_kvw_18:
  s_sub_u32 s100, s100, 1
  s_cbranch_scc1 L_end
  buffer_load_dwordx2 v[16:17], v8, s[8:11], s52 offen sc1
  s_waitcnt vmcnt(0)
  v_subrev_u32 v10, s30, v16
  v_bfe_u32 v11, v8, 3, 2
  v_cmp_eq_u32 s[70:71], s31, v17
  v_mad_u32_u24 v10, v10, 3, v11
  s_add_u32 s48, s49, 1
  s_min_u32 s48, s48, 63
  v_cmp_lt_u32 s[38:39], 63, v10
  v_cmp_lt_u32 s[94:95], s48, v10
  v_cmp_lt_u32 vcc, s49, v10
  s_and_b32 s38, s38, s70
  s_andn2_b32 s60, 0x7777, s38
  s_andn2_b32 s38, 0x7777, s94
  s_cselect_b32 s32, -1, 0xffff0000
  s_and_b32 s38, vcc_lo, s70
  s_andn2_b32 s38, 0x7777, s38
  s_cbranch_scc1 L_kvw_18
  s_branch L_T_chkb_f
L_T_r2_x:
  s_mov_b64 exec, s[90:91]
  buffer_load_dwordx4 v[40:43], v3, s[8:11], s45 offen sc1
  s_mov_b64 exec, s[92:93]
  buffer_load_dwordx4 v[44:47], v3, s[8:11], s45 offen offset:1024 sc1
  s_mov_b64 exec, -1
  s_sub_u32 s100, s100, 1
  s_cbranch_scc1 L_end
L_T_r2a_x:
  v_mov_b64 v[72:73], 0
  v_mov_b64 v[74:75], 0
  v_mov_b64 v[76:77], 0
  v_mov_b64 v[78:79], 0
  s_waitcnt vmcnt(3)
  v_max3_u32 v10, v40, v41, v42
  v_max_u32 v10, v43, v10
  v_smfmac_f32_16x16x64_bf16 v[72:75], v[40:43], v[48:55], v1
  ds_write_b128 v3, v[40:43] offset:40960
  s_waitcnt vmcnt(2)
  v_max3_u32 v11, v44, v45, v46
  v_max_u32 v11, v47, v11
  v_cmp_eq_u32 s[90:91], -1, v10
  v_cmp_eq_u32 s[92:93], -1, v11
  v_smfmac_f32_16x16x64_bf16 v[76:79], v[40:43], v[56:63], v1
  s_or_b64 s[94:95], s[90:91], s[92:93]
  s_cbranch_scc1 L_T_r2_x
  ds_write_b128 v3, v[44:47] offset:41984
  s_branch L_T_e_x
L_T_first_x:
  v_smfmac_f32_16x16x64_bf16 v[72:75], v[40:43], v[48:55], v1
  ds_write_b128 v3, v[40:43] offset:40960
  v_smfmac_f32_16x16x64_bf16 v[76:79], v[40:43], v[56:63], v1
  ds_write_b128 v3, v[44:47] offset:41984
  s_branch L_T_e_x
.p2align 6
L_T_p2_x:
L_T_loop_x:
  s_waitcnt vmcnt(3)
  v_max3_u32 v10, v40, v41, v42
  v_max_u32 v10, v43, v10
  v_smfmac_f32_16x16x64_bf16 v[72:75], v[40:43], v[48:55], v1
  ds_write_b128 v3, v[40:43] offset:40960
  s_waitcnt vmcnt(2)
  v_max3_u32 v11, v44, v45, v46
  v_max_u32 v11, v47, v11
  v_cmp_eq_u32 s[90:91], -1, v10
  v_cmp_eq_u32 s[92:93], -1, v11
  v_smfmac_f32_16x16x64_bf16 v[76:79], v[40:43], v[56:63], v1
  s_or_b64 s[94:95], s[90:91], s[92:93]
  s_cbranch_scc1 L_T_r2_x
L_T_w1_x:
  ds_write_b128 v3, v[44:47] offset:41984
L_T_e_x:
  v_smfmac_f32_16x16x64_bf16 v[80:83], v[40:43], v[64:71], v1
  s_add_u32 s45, s45, 0x2000
  s_andn2_b32 s45, s45, 0x8000
  s_xor_b32 s46, s45, 0x4000
  v_smfmac_f32_16x16x64_bf16 v[84:87], v[40:43], v[32:39], v1
  v_mov_b64_e64 v[24:25], -1
  v_smfmac_f32_16x16x64_bf16 v[72:75], v[44:47], v[96:103], v1
  v_mov_b64_e64 v[26:27], -1
  v_smfmac_f32_16x16x64_bf16 v[76:79], v[44:47], v[104:111], v1
  v_smfmac_f32_16x16x64_bf16 v[80:83], v[44:47], v[112:119], v1
  buffer_store_dwordx4 v[24:27], v3, s[8:11], s44 offen offset:1024 sc1
  v_smfmac_f32_16x16x64_bf16 v[84:87], v[44:47], v[120:127], v1
  buffer_store_dwordx4 v[24:27], v3, s[8:11], s44 offen sc1
  s_waitcnt lgkmcnt(0)
  s_barrier
  ds_read_b128 v[48:51], v4 offset:40960
  ds_read_b128 v[52:55], v4 offset:41984
  v_smfmac_f32_16x16x64_bf16 v[88:91], v[40:43], v[128:135], v1
  ds_read_b128 v[56:59], v5 offset:40960
  s_mov_b32 m0, s50
  v_smfmac_f32_16x16x64_bf16 v[92:95], v[40:43], v[192:199], v1
  ds_read_b128 v[60:63], v5 offset:41984
  s_cmp_eq_u32 s40, 63
  v_smfmac_f32_16x16x64_bf16 v[88:91], v[44:47], v[136:143], v1
  ds_read_b128 v[64:67], v6 offset:40960
  v_smfmac_f32_16x16x64_bf16 v[92:95], v[44:47], v[200:207], v1
  ds_read_b128 v[68:71], v6 offset:41984
  s_cbranch_scc1 L_T_fin
  s_waitcnt lgkmcnt(5)
  v_smfmac_f32_16x16x64_bf16 v[72:75], v[48:51], a[16:23], v1
  buffer_load_dwordx4 v[24:27], v3, s[8:11], s55 offen offset:0 sc1
  v_smfmac_f32_16x16x64_bf16 v[76:79], v[48:51], a[80:87], v1
  s_waitcnt lgkmcnt(4)
  v_smfmac_f32_16x16x64_bf16 v[72:75], v[52:55], a[24:31], v1
  buffer_load_dwordx4 v[28:31], v3, s[8:11], s55 offen offset:1024 sc1
  v_smfmac_f32_16x16x64_bf16 v[76:79], v[52:55], a[88:95], v1
  s_waitcnt lgkmcnt(3)
  v_smfmac_f32_16x16x64_bf16 v[72:75], v[56:59], a[32:39], v1
  buffer_load_dwordx4 v3, s[8:11], s41 offen sc1 lds
  v_smfmac_f32_16x16x64_bf16 v[76:79], v[56:59], a[96:103], v1
  s_waitcnt lgkmcnt(2)
  v_smfmac_f32_16x16x64_bf16 v[72:75], v[60:63], a[40:47], v1
  buffer_load_dwordx4 v3, s[8:11], s41 offen offset:1024 sc1 lds
  v_smfmac_f32_16x16x64_bf16 v[76:79], v[60:63], a[104:111], v1
  s_waitcnt lgkmcnt(1)
  v_smfmac_f32_16x16x64_bf16 v[72:75], v[64:67], a[48:55], v1
  s_mov_b64 exec, s[32:33]
  buffer_load_dwordx2 v[16:17], v14, s[8:11], 0 offen sc1
  s_mov_b64 exec, -1
  v_smfmac_f32_16x16x64_bf16 v[76:79], v[64:67], a[112:119], v1
  buffer_store_dwordx4 v[18:21], v3, s[8:11], s42 offen sc1
  s_add_u32 s42, s42, 131072
  s_waitcnt lgkmcnt(0)
  v_smfmac_f32_16x16x64_bf16 v[72:75], v[68:71], a[56:63], v1
  ds_read_b128 v[96:99], v2 offset:0
  v_smfmac_f32_16x16x64_bf16 v[76:79], v[68:71], a[120:127], v1
  ds_read_b128 v[100:103], v2 offset:1024
  v_smfmac_f32_16x16x64_bf16 v[80:83], v[48:51], a[144:151], v1
  ds_read_b128 v[104:107], v2 offset:2048
  v_mov_b64 v[32:33], 0
  v_smfmac_f32_16x16x64_bf16 v[84:87], v[48:51], a[208:215], v1
  ds_read_b128 v[108:111], v2 offset:3072
  v_add_f32_e64 v72, v72, v74
  v_smfmac_f32_16x16x64_bf16 v[80:83], v[52:55], a[152:159], v1
  ds_read_b128 v[112:115], v2 offset:4096
  v_add_f32_e64 v73, v73, v75
  v_smfmac_f32_16x16x64_bf16 v[84:87], v[52:55], a[216:223], v1
  ds_read_b128 v[116:119], v2 offset:5120
  v_add_f32_e64 v76, v76, v78
  v_smfmac_f32_16x16x64_bf16 v[80:83], v[56:59], a[160:167], v1
  ds_read_b128 v[120:123], v2 offset:6144
  v_add_f32_e64 v77, v77, v79
  v_smfmac_f32_16x16x64_bf16 v[84:87], v[56:59], a[224:231], v1
  ds_read_b128 v[124:127], v2 offset:7168
  v_cvt_pk_bf16_f32 v72, v72, v73
  v_smfmac_f32_16x16x64_bf16 v[80:83], v[60:63], a[168:175], v1
  ds_write2_b32 v7, v72, v72 offset0:0 offset1:1
  v_cvt_pk_bf16_f32 v76, v76, v77
  v_smfmac_f32_16x16x64_bf16 v[84:87], v[60:63], a[232:239], v1
  ds_write2_b32 v7, v76, v76 offset0:128 offset1:129
  v_mov_b64_e64 v[34:35], 0
  v_smfmac_f32_16x16x64_bf16 v[80:83], v[64:67], a[176:183], v1
  v_mov_b32 v36, 0x3f803f80
  v_smfmac_f32_16x16x64_bf16 v[84:87], v[64:67], a[240:247], v1
  v_mov_b32 v37, 0x3f803f80
  v_smfmac_f32_16x16x64_bf16 v[80:83], v[68:71], a[184:191], v1
  v_mov_b32 v38, 0x3f803f80
  v_smfmac_f32_16x16x64_bf16 v[84:87], v[68:71], a[248:255], v1
  s_nop 0
  s_nop 0
  v_mov_b32 v39, 0x3f803f80
  v_smfmac_f32_16x16x64_bf16 v[88:91], v[48:51], v[144:151], v1
  s_nop 1
  v_add_f32 v80, v80, v82
  v_add_f32 v81, v81, v83
  v_add_f32 v84, v84, v86
  v_add_f32_e64 v85, v85, v87
  v_cvt_pk_bf16_f32 v18, v80, v81
  v_cvt_pk_bf16_f32 v19, v84, v85
  v_smfmac_f32_16x16x64_bf16 v[92:95], v[48:51], v[208:215], v1
  ds_write2st64_b32 v7, v18, v19 offset0:16 offset1:18
  v_smfmac_f32_16x16x64_bf16 v[88:91], v[52:55], v[152:159], v1
  v_smfmac_f32_16x16x64_bf16 v[92:95], v[52:55], v[216:223], v1
  v_smfmac_f32_16x16x64_bf16 v[88:91], v[56:59], v[160:167], v1
  v_smfmac_f32_16x16x64_bf16 v[92:95], v[56:59], v[224:231], v1
  s_waitcnt vmcnt(4)
  v_smfmac_f32_16x16x64_bf16 v[88:91], v[60:63], v[168:175], v1
  s_waitcnt lgkmcnt(0)
  s_barrier
  ds_read_b64_tr_b16 v[72:73], v8 offset:0
  ds_read_b64_tr_b16 v[74:75], v8 offset:512
  v_smfmac_f32_16x16x64_bf16 v[92:95], v[60:63], v[232:239], v1
  ds_read_b64_tr_b16 v[76:77], v8 offset:1024
  ds_read_b64_tr_b16 v[78:79], v8 offset:1536
  v_smfmac_f32_16x16x64_bf16 v[88:91], v[64:67], v[176:183], v1
  ds_read_b64_tr_b16 v[80:81], v8 offset:2048
  ds_read_b64_tr_b16 v[82:83], v8 offset:2560
  v_smfmac_f32_16x16x64_bf16 v[92:95], v[64:67], v[240:247], v1
  ds_read_b64_tr_b16 v[84:85], v8 offset:3072
  ds_read_b64_tr_b16 v[86:87], v8 offset:3584
  v_smfmac_f32_16x16x64_bf16 v[88:91], v[68:71], v[184:191], v1
  ds_read_b64_tr_b16 v[40:41], v8 offset:4096
  v_smfmac_f32_16x16x64_bf16 v[92:95], v[68:71], v[248:255], v1
  ds_read_b64_tr_b16 v[42:43], v8 offset:4608
  s_waitcnt lgkmcnt(6)
  v_mfma_f32_16x16x32_bf16 v[56:59], v[96:99], v[72:75], 0
  ds_read_b64_tr_b16 v[44:45], v8 offset:5120
  v_add_u32_e64 v11, s56, v2
  v_mfma_f32_16x16x32_bf16 v[60:63], v[112:115], v[72:75], 0
  ds_read_b64_tr_b16 v[46:47], v8 offset:5632
  v_mov_b64_e64 v[96:97], 0
  v_mfma_f32_16x16x32_bf16 v[56:59], v[100:103], v[76:79], v[56:59]
  ds_read_b64_tr_b16 v[48:49], v8 offset:6144
  v_mov_b64_e64 v[98:99], 0
  v_mfma_f32_16x16x32_bf16 v[60:63], v[116:119], v[76:79], v[60:63]
  ds_read_b64_tr_b16 v[50:51], v8 offset:6656
  s_waitcnt lgkmcnt(6)
  v_mfma_f32_16x16x32_bf16 v[56:59], v[104:107], v[80:83], v[56:59]
  ds_read_b64_tr_b16 v[52:53], v8 offset:7168
  v_mov_b64 v[100:101], 0
  v_mfma_f32_16x16x32_bf16 v[60:63], v[120:123], v[80:83], v[60:63]
  ds_read_b64_tr_b16 v[54:55], v8 offset:7680
  v_mov_b64_e64 v[102:103], 0
  v_mfma_f32_16x16x32_bf16 v[56:59], v[108:111], v[84:87], v[56:59]
  v_add_f32 v88, v88, v90
  v_add_f32 v89, v89, v91
  v_mfma_f32_16x16x32_bf16 v[60:63], v[124:127], v[84:87], v[60:63]
  s_waitcnt lgkmcnt(4)
  v_add_f32 v92, v92, v94
  v_add_f32_e64 v93, v93, v95
  v_mfma_f32_16x16x32_bf16 v[64:67], v[40:43], v[72:75], 0
  v_cvt_pk_bf16_f32 v20, v88, v89
  v_cvt_pk_bf16_f32 v21, v92, v93
  v_mfma_f32_16x16x32_bf16 v[64:67], v[44:47], v[76:79], v[64:67]
  s_waitcnt lgkmcnt(2)
  v_mfma_f32_16x16x32_bf16 v[64:67], v[48:51], v[80:83], v[64:67]
  s_waitcnt lgkmcnt(0)
  v_max3_f32 v92, v56, v57, v58
  v_max3_f32 v92, v59, v60, v92
  v_mfma_f32_16x16x32_bf16 v[64:67], v[52:55], v[84:87], v[64:67]
  s_add_u32 s40, s40, 1
  v_max3_f32 v92, v61, v62, v92
  v_max_f32 v92, v63, v92
  v_mov_b64 v[104:105], 0
  v_mov_b64 v[106:107], 0
  v_mov_b64 v[108:109], 0
  v_mov_b64_e64 v[110:111], 0
  s_nop 0
  v_max3_f32 v66, v64, v65, v92
  v_max3_f32 v67, v64, v65, v92
  v_mov_b64 v[88:89], 0
  v_mov_b64 v[90:91], 0
  v_permlane16_swap_b32 v66, v67
  v_max_f32 v92, v66, v67
  v_max_f32 v93, v66, v67
  v_mov_b64 v[72:73], -1
  v_mov_b64 v[74:75], -1
  v_permlane32_swap_b32 v92, v93
  v_max_f32 v66, v92, v93
  v_mul_f32 v66, s47, v66
  v_pk_fma_f32 v[64:65], v[64:65], s[66:67], v[66:67] op_sel_hi:[1,1,0]
  v_pk_fma_f32 v[56:57], v[56:57], s[66:67], v[66:67] op_sel_hi:[1,1,0]
  v_pk_fma_f32 v[58:59], v[58:59], s[66:67], v[66:67] op_sel_hi:[1,1,0]
  v_pk_fma_f32 v[60:61], v[60:61], s[66:67], v[66:67] op_sel_hi:[1,1,0]
  v_pk_fma_f32 v[62:63], v[62:63], s[66:67], v[66:67] op_sel_hi:[1,1,0]
  v_exp_f32 v64, v64
  v_exp_f32 v65, v65
  v_exp_f32_e64 v56, v56
  v_cvt_pk_bf16_f32 v66, v64, v65
  v_cndmask_b32 v32, 0, v66, s[62:63]
  v_cndmask_b32 v33, 0, v66, s[64:65]
  v_exp_f32 v57, v57
  v_exp_f32 v58, v58
  v_mfma_f32_16x16x32_bf16 v[68:71], v[36:39], v[32:35], 0
  ds_read_b128 v[112:115], v15 offset:16384
  v_exp_f32 v59, v59
  v_exp_f32 v60, v60
  v_mfma_f32_16x16x32_bf16 v[92:95], v[20:23], v[32:35], 0
  ds_read_b128 v[116:119], v15 offset:17408
  v_exp_f32 v61, v61
  v_exp_f32 v62, v62
  v_exp_f32 v63, v63
  s_mov_b64 exec, s[62:63]
  v_cvt_pk_bf16_f32 v96, v56, v57
  v_cvt_pk_bf16_f32 v97, v58, v59
  v_cvt_pk_bf16_f32 v98, v60, v61
  v_cvt_pk_bf16_f32 v99, v62, v63
  s_mov_b64 exec, s[64:65]
  v_cvt_pk_bf16_f32 v100, v56, v57
  v_mfma_f32_16x16x32_bf16 v[68:71], v[36:39], v[96:99], v[68:71]
  v_cvt_pk_bf16_f32 v101, v58, v59
  v_cvt_pk_bf16_f32 v102, v60, v61
  v_mfma_f32_16x16x32_bf16 v[92:95], v[24:27], v[96:99], v[92:95]
  v_cvt_pk_bf16_f32 v103, v62, v63
  s_mov_b64 exec, -1
  s_nop 0
  v_mfma_f32_16x16x32_bf16 v[92:95], v[28:31], v[100:103], v[92:95]
  s_nop 0
  v_rcp_f32_dpp v68, v68 quad_perm:[0,1,0,1] row_mask:0xf bank_mask:0xf
  v_mov_b64 v[64:65], 0
  v_mov_b64 v[66:67], 0
  v_mov_b64 v[96:97], 0
  v_mov_b64 v[98:99], 0
  v_mov_b64 v[100:101], 0
  v_mov_b64 v[102:103], 0
  v_pk_mul_f32 v[92:93], v[92:93], v[68:69] op_sel_hi:[1,0]
  v_pk_mul_f32 v[94:95], v[94:95], v[68:69] op_sel_hi:[1,0]
  v_cvt_pk_bf16_f32 v56, v92, v93
  v_cvt_pk_bf16_f32 v57, v94, v95
  ds_write_b64 v11, v[56:57]
  ds_read_b128 v[120:123], v15 offset:18432
  ds_read_b128 v[124:127], v15 offset:19456
  v_mov_b64 v[92:93], 0
  v_mov_b64_e64 v[94:95], 0
  s_nop 1
  ds_read_b128 v[40:43], v15 offset:20480
  ds_read_b128 v[44:47], v15 offset:21504
  v_mov_b64 v[68:69], 0
  v_mov_b64 v[70:71], 0
  s_waitcnt lgkmcnt(4)
  s_barrier
  ds_read_b128 v[56:59], v2 offset:0
  ds_read_b128 v[60:63], v2 offset:1024
  v_mov_b32 v0, v22
  s_mov_b64 exec, s[68:69]
  buffer_store_dword v72, v13, s[8:11], s46 offen sc1
  s_mov_b64 exec, -1
  ds_read_b128 v[48:51], v15 offset:22528
  ds_read_b128 v[52:55], v15 offset:23552
  v_mov_b32_e64 v0, v22
  s_waitcnt lgkmcnt(3)
  v_smfmac_f32_16x16x64_bf16 v[104:107], v[56:59], a[0:7], v1
  ds_read_b128 v[72:75], v15 offset:24576
  s_waitcnt lgkmcnt(3)
  v_smfmac_f32_16x16x64_bf16 v[104:107], v[60:63], a[64:71], v1
  ds_read_b128 v[76:79], v15 offset:25600
  v_xor_b32 v2, 81920, v2
  v_smfmac_f32_16x16x64_bf16 v[108:111], v[56:59], a[128:135], v1
  ds_read_b128 v[80:83], v15 offset:26624
  v_smfmac_f32_16x16x64_bf16 v[108:111], v[60:63], a[192:199], v1
  ds_read_b128 v[84:87], v15 offset:27648
  v_smfmac_f32_16x16x64_bf16 v[88:91], v[56:59], a[8:15], v1
  ds_read_b128 v[24:27], v15 offset:28672
  v_add_f32 v104, v104, v106
  v_smfmac_f32_16x16x64_bf16 v[88:91], v[60:63], a[72:79], v1
  ds_read_b128 v[28:31], v15 offset:29696
  v_add_f32_e64 v105, v105, v107
  v_smfmac_f32_16x16x64_bf16 v[64:67], v[56:59], a[136:143], v1
  ds_read_b128 v[32:35], v15 offset:30720
  v_add_f32 v108, v108, v110
  v_add_f32 v109, v109, v111
  v_smfmac_f32_16x16x64_bf16 v[64:67], v[60:63], a[200:207], v1
  ds_read_b128 v[36:39], v15 offset:31744
  v_cvt_pk_bf16_f32 v104, v104, v108
  v_cvt_pk_bf16_f32 v105, v105, v109
  v_smfmac_f32_16x16x64_bf16 v[96:99], v[56:59], v[112:119], v1
  buffer_store_dwordx2 v[104:105], v12, s[8:11], s43 offen sc1
  v_add_f32 v88, v88, v90
  v_add_f32 v89, v89, v91
  v_smfmac_f32_16x16x64_bf16 v[96:99], v[60:63], v[120:127], v1
  s_waitcnt lgkmcnt(6)
  s_nop 0
  v_add_f32 v64, v64, v66
  v_add_f32 v65, v65, v67
  v_smfmac_f32_16x16x64_bf16 v[100:103], v[56:59], v[40:47], v1
  s_nop 0
  s_nop 0
  v_cvt_pk_bf16_f32 v88, v88, v64
  v_cvt_pk_bf16_f32 v89, v89, v65
  v_smfmac_f32_16x16x64_bf16 v[100:103], v[60:63], v[48:55], v1
  buffer_store_dwordx2 v[88:89], v12, s[8:11], s53 offen sc1
  s_nop 0
  v_add_f32 v96, v96, v98
  v_smfmac_f32_16x16x64_bf16 v[92:95], v[56:59], v[72:79], v1
  s_waitcnt lgkmcnt(2)
  s_nop 0
  v_add_f32_e64 v97, v97, v99
  v_smfmac_f32_16x16x64_bf16 v[92:95], v[60:63], v[80:87], v1
  s_nop 1
  v_add_f32 v100, v100, v102
  v_add_f32_e64 v101, v101, v103
  v_smfmac_f32_16x16x64_bf16 v[68:71], v[56:59], v[24:31], v1
  s_waitcnt lgkmcnt(0)
  s_nop 0
  v_cvt_pk_bf16_f32 v96, v96, v100
  v_cvt_pk_bf16_f32 v97, v97, v101
  v_smfmac_f32_16x16x64_bf16 v[68:71], v[60:63], v[32:39], v1
  buffer_store_dwordx2 v[96:97], v12, s[8:11], s51 offen sc1
  v_add_f32 v92, v92, v94
  v_add_f32 v93, v93, v95
  s_nop 4
  v_add_f32 v68, v68, v70
  v_add_f32_e64 v69, v69, v71
  v_cvt_pk_bf16_f32 v92, v92, v68
  v_cvt_pk_bf16_f32 v93, v93, v69
  buffer_store_dwordx2 v[92:93], v12, s[8:11], s57 offen sc1
  s_barrier
  v_mov_b64 v[40:41], 0
  v_mov_b64_e64 v[42:43], 0
  s_xor_b32 s43, s43, 0x40000
  s_xor_b32 s53, s53, 0x40000
  s_xor_b32 s51, s51, 0x40000
  ds_read_b128 v[48:51], v15 offset:8192
  ds_read_b128 v[52:55], v15 offset:9216
  s_nop 0
  v_mov_b64 v[72:73], 0
  v_mov_b64_e64 v[74:75], 0
  s_xor_b32 s57, s57, 0x40000
  s_xor_b32 s44, s44, 0x40000
  s_nop 0
  ds_read_b128 v[56:59], v15 offset:12288
  ds_read_b128 v[60:63], v15 offset:13312
  s_nop 0
  v_mov_b32_dpp v40, v9 quad_perm:[0,1,2,3] row_mask:0xf bank_mask:0x1
  v_mov_b32_dpp v41, v9 quad_perm:[0,1,2,3] row_mask:0xf bank_mask:0x2
  s_nop 1
  s_cmp_le_u32 s26, 0
  s_cbranch_scc1 L_T_sg_x
  v_mov_b32 v0, v22
  s_nop 3
  s_cmp_le_u32 s26, 1
  s_cbranch_scc1 L_T_sg_x
  v_mov_b32 v0, v22
  s_nop 3
  s_cmp_le_u32 s26, 2
  s_cbranch_scc1 L_T_sg_x
  v_mov_b32_e64 v0, v22
  s_nop 3
L_T_sg_x:
  buffer_load_dwordx4 v[24:27], v3, s[8:11], s54 offen sc1
  buffer_load_dwordx4 v[28:31], v3, s[8:11], s54 offen offset:1024 sc1
  v_mov_b32_dpp v42, v9 quad_perm:[0,1,2,3] row_mask:0xf bank_mask:0x4
  v_mov_b32_dpp v43, v9 quad_perm:[0,1,2,3] row_mask:0xf bank_mask:0x8
  s_add_u32 s55, s41, 8192
  s_cmp_lt_u32 s40, 63
  s_cselect_b32 s48, 524288, 0
  ds_read_b128 v[64:67], v15 offset:0
  ds_read_b128 v[68:71], v15 offset:1024
  s_nop 0
  v_mov_b64 v[76:77], 0
  v_mov_b64_e64 v[78:79], 0
  s_add_u32 s41, s41, s48
  s_xor_b32 s50, s50, 81920
  s_nop 0
  ds_read_b128 v[32:35], v15 offset:4096
  ds_read_b128 v[36:39], v15 offset:5120
  s_nop 0
  v_mov_b64 v[80:81], 0
  v_mov_b64 v[82:83], 0
  s_mov_b32 exec_lo, 0xffff0000
  v_add_u32 v14, s48, v14
  s_mov_b32 exec_lo, -1
  ds_read_b128 v[96:99], v15 offset:10240
  ds_read_b128 v[100:103], v15 offset:11264
  s_nop 0
  v_mov_b64 v[84:85], 0
  v_mov_b64_e64 v[86:87], 0
  s_nop 1
  s_mov_b64 exec, s[34:35]
  buffer_load_dwordx4 v[24:27], v3, s[8:11], s54 offen sc1
  buffer_load_dwordx4 v[28:31], v3, s[8:11], s54 offen offset:1024 sc1
  s_mov_b64 exec, -1
  v_mov_b64 v[88:89], 0
  v_mov_b64 v[90:91], 0
  s_nop 2
  ds_read_b128 v[104:107], v15 offset:14336
  ds_read_b128 v[108:111], v15 offset:15360
  s_nop 0
  s_waitcnt vmcnt(3)
  v_max3_u32 v10, v24, v25, v26
  v_max_u32_e64 v10, v27, v10
  v_mfma_f32_16x16x32_bf16 v[44:47], v[40:43], v[24:27], 0
  s_waitcnt vmcnt(2)
  v_max3_u32 v11, v28, v29, v30
  v_max_u32 v11, v31, v11
  v_mfma_f32_16x16x32_bf16 v[44:47], v[40:43], v[28:31], v[44:47]
  v_cmp_eq_u32 s[90:91], -1, v10
  v_cmp_eq_u32 s[92:93], -1, v11
  s_nop 0
  s_or_b64 s[94:95], s[90:91], s[92:93]
  s_cbranch_scc1 L_T_r1_x
L_T_g1_x:
  s_nop 2
  v_add_f32_dpp v44, v44, v44 row_ror:8 row_mask:0xf bank_mask:0xf
  v_add_f32_dpp v45, v45, v45 row_ror:8 row_mask:0xf bank_mask:0xf
  s_nop 0
  v_add_f32_dpp v44, v44, v44 row_ror:4 row_mask:0xf bank_mask:0xf
  v_add_f32_dpp v45, v45, v45 row_ror:4 row_mask:0xf bank_mask:0xf
  s_mov_b64 exec, s[68:69]
  v_cvt_pk_bf16_f32 v10, v44, v45
  buffer_store_dword v10, v13, s[8:11], s45 offen sc1
  s_mov_b64 exec, -1
  s_barrier
  s_xor_b32 s54, s54, 0x40000
  s_nop 0
  s_nop 0
  v_mov_b64 v[92:93], 0
  v_mov_b64_e64 v[94:95], 0
  s_nop 2
  ds_read_b128 v[112:115], v15 offset:2048
  ds_read_b128 v[116:119], v15 offset:3072
  s_nop 0
  v_mov_b32 v0, v22
  v_mov_b32 v0, v22
  s_nop 2
  ds_read_b128 v[120:123], v15 offset:6144
  ds_read_b128 v[124:127], v15 offset:7168
  s_nop 0
  v_mov_b32_e64 v0, v22
  s_nop 2
  buffer_load_dwordx4 v[40:43], v3, s[8:11], s45 offen sc1
  buffer_load_dwordx4 v[44:47], v3, s[8:11], s45 offen offset:1024 sc1
  s_cmp_lg_u32 s60, 0
  s_cbranch_scc1 L_T_chk_x
  v_mov_b32 v0, v22
  s_nop 2
  v_mov_b32 v0, v22
  s_nop 2
  v_mov_b32 v0, v22
  s_nop 2
  v_mov_b32 v0, v22
  s_nop 2
  v_mov_b32 v0, v22
  s_nop 2
  v_mov_b32 v0, v22
  s_nop 2
  v_mov_b32 v0, v22
  s_nop 2
  v_mov_b32 v0, v22
  s_nop 2
L_T_chkb_x:
  buffer_load_dwordx4 v[40:43], v3, s[8:11], s45 offen sc1
  buffer_load_dwordx4 v[44:47], v3, s[8:11], s45 offen offset:1024 sc1
  s_waitcnt lgkmcnt(0)
  s_branch L_T_p2_x
L_T_r1_x:
  s_mov_b64 exec, s[90:91]
  buffer_load_dwordx4 v[24:27], v3, s[8:11], s54 offen sc1
  s_mov_b64 exec, s[92:93]
  buffer_load_dwordx4 v[28:31], v3, s[8:11], s54 offen offset:1024 sc1
  s_mov_b64 exec, -1
  s_sub_u32 s100, s100, 1
  s_cbranch_scc1 L_end
L_T_r1a_x:
  v_mov_b32 v0, v22
  s_waitcnt vmcnt(3)
  v_max3_u32 v10, v24, v25, v26
  v_max_u32 v10, v27, v10
  v_mfma_f32_16x16x32_bf16 v[44:47], v[40:43], v[24:27], 0
  s_waitcnt vmcnt(2)
  v_max3_u32 v11, v28, v29, v30
  v_max_u32 v11, v31, v11
  v_mfma_f32_16x16x32_bf16 v[44:47], v[40:43], v[28:31], v[44:47]
  v_cmp_eq_u32 s[90:91], -1, v10
  v_cmp_eq_u32 s[92:93], -1, v11
  s_nop 0
  s_or_b64 s[94:95], s[90:91], s[92:93]
  s_cbranch_scc1 L_T_r1_x
  s_branch L_T_g1_x
L_T_chk_x:
  s_add_u32 s49, s40, 1
  s_min_u32 s49, s49, 63
  v_subrev_u32 v10, s30, v16
  v_bfe_u32 v11, v8, 3, 2
  v_cmp_eq_u32 s[70:71], s31, v17
  v_mad_u32_u24 v10, v10, 3, v11
  s_add_u32 s48, s49, 1
  s_min_u32 s48, s48, 63
  v_cmp_lt_u32 s[38:39], 63, v10
  v_cmp_lt_u32 s[94:95], s48, v10
  v_cmp_lt_u32 vcc, s49, v10
  s_and_b32 s38, s38, s70
  s_andn2_b32 s60, 0x7777, s38
  s_andn2_b32 s38, 0x7777, s94
  s_cselect_b32 s32, -1, 0xffff0000
  s_and_b32 s38, vcc_lo, s70
  s_andn2_b32 s38, 0x7777, s38
  s_cbranch_scc0 L_T_chkb_x
L_kvw_19:
  s_sub_u32 s100, s100, 1
  s_cbranch_scc1 L_end
  buffer_load_dwordx2 v[16:17], v8, s[8:11], s52 offen sc1
  s_waitcnt vmcnt(0)
  v_subrev_u32 v10, s30, v16
  v_bfe_u32 v11, v8, 3, 2
  v_cmp_eq_u32 s[70:71], s31, v17
  v_mad_u32_u24 v10, v10, 3, v11
  s_add_u32 s48, s49, 1
  s_min_u32 s48, s48, 63
  v_cmp_lt_u32 s[38:39], 63, v10
  v_cmp_lt_u32 s[94:95], s48, v10
  v_cmp_lt_u32 vcc, s49, v10
  s_and_b32 s38, s38, s70
  s_andn2_b32 s60, 0x7777, s38
  s_andn2_b32 s38, 0x7777, s94
  s_cselect_b32 s32, -1, 0xffff0000
  s_and_b32 s38, vcc_lo, s70
  s_andn2_b32 s38, 0x7777, s38
  s_cbranch_scc1 L_kvw_19
  s_branch L_T_chkb_x
L_T_fin:
  buffer_store_dwordx4 v[18:21], v3, s[8:11], s42 offen sc1
  s_add_u32 s42, s42, 131072
  s_waitcnt lgkmcnt(5)
  v_smfmac_f32_16x16x64_bf16 v[80:83], v[48:51], a[144:151], v1
  v_smfmac_f32_16x16x64_bf16 v[88:91], v[48:51], v[144:151], v1
  v_smfmac_f32_16x16x64_bf16 v[84:87], v[48:51], a[208:215], v1
  v_smfmac_f32_16x16x64_bf16 v[92:95], v[48:51], v[208:215], v1
  s_waitcnt lgkmcnt(4)
  v_smfmac_f32_16x16x64_bf16 v[80:83], v[52:55], a[152:159], v1
  v_smfmac_f32_16x16x64_bf16 v[88:91], v[52:55], v[152:159], v1
  v_smfmac_f32_16x16x64_bf16 v[84:87], v[52:55], a[216:223], v1
  v_smfmac_f32_16x16x64_bf16 v[92:95], v[52:55], v[216:223], v1
  s_waitcnt lgkmcnt(3)
  v_smfmac_f32_16x16x64_bf16 v[80:83], v[56:59], a[160:167], v1
  v_smfmac_f32_16x16x64_bf16 v[88:91], v[56:59], v[160:167], v1
  v_smfmac_f32_16x16x64_bf16 v[84:87], v[56:59], a[224:231], v1
  v_smfmac_f32_16x16x64_bf16 v[92:95], v[56:59], v[224:231], v1
  s_waitcnt lgkmcnt(2)
  v_smfmac_f32_16x16x64_bf16 v[80:83], v[60:63], a[168:175], v1
  v_smfmac_f32_16x16x64_bf16 v[88:91], v[60:63], v[168:175], v1
  v_smfmac_f32_16x16x64_bf16 v[84:87], v[60:63], a[232:239], v1
  v_smfmac_f32_16x16x64_bf16 v[92:95], v[60:63], v[232:239], v1
  s_waitcnt lgkmcnt(1)
  v_smfmac_f32_16x16x64_bf16 v[80:83], v[64:67], a[176:183], v1
  v_smfmac_f32_16x16x64_bf16 v[88:91], v[64:67], v[176:183], v1
  v_smfmac_f32_16x16x64_bf16 v[84:87], v[64:67], a[240:247], v1
  v_smfmac_f32_16x16x64_bf16 v[92:95], v[64:67], v[240:247], v1
  s_waitcnt lgkmcnt(0)
  v_smfmac_f32_16x16x64_bf16 v[80:83], v[68:71], a[184:191], v1
  v_smfmac_f32_16x16x64_bf16 v[88:91], v[68:71], v[184:191], v1
  v_smfmac_f32_16x16x64_bf16 v[84:87], v[68:71], a[248:255], v1
  v_smfmac_f32_16x16x64_bf16 v[92:95], v[68:71], v[248:255], v1
  s_nop 4
  v_add_f32 v80, v80, v82
  v_add_f32 v81, v81, v83
  v_cvt_pk_bf16_f32 v18, v80, v81
  v_add_f32 v84, v84, v86
  v_add_f32 v85, v85, v87
  v_cvt_pk_bf16_f32 v19, v84, v85
  v_add_f32 v88, v88, v90
  v_add_f32 v89, v89, v91
  v_cvt_pk_bf16_f32 v20, v88, v89
  v_add_f32 v92, v92, v94
  v_add_f32 v93, v93, v95
  v_cvt_pk_bf16_f32 v21, v92, v93
  buffer_store_dwordx4 v[18:21], v3, s[8:11], s42 offen sc1
L_end:
  s_endpgm
.section .rodata,"a"
.p2align 6
.amdhsa_kernel gated_mix__memory_aug_recurrent_mem_tr__glu_gated_reglu__prompt_kernel
  .amdhsa_next_free_vgpr 512
  .amdhsa_next_free_sgpr 102
  .amdhsa_accum_offset 256
  .amdhsa_group_segment_fixed_size 0
  .amdhsa_kernarg_size 120
  .amdhsa_user_sgpr_count 2
  .amdhsa_user_sgpr_kernarg_segment_ptr 1
  .amdhsa_system_sgpr_workgroup_id_x 1
.end_amdhsa_kernel
```
